```python
import torch

def _softmax(x, axis=-1):
    return torch.softmax(x, dim=axis)

def _gelu(x):
    return torch.nn.functional.gelu(x, approximate='tanh')

def _silu(x):
    return torch.nn.functional.silu(x)

def _sigmoid(x):
    return torch.sigmoid(x)

def _layernorm(x, axis=-1, eps=1e-05):
    m = x.mean(dim=axis, keepdim=True)
    v = x.var(dim=axis, keepdim=True, unbiased=False)
    return (x - m) / torch.sqrt(v + eps)

def _scatter_add(tgt, idx, src, axis=0):
    return tgt.clone().index_add_(axis, idx, src)

def _segment_sum(src, seg, n):
    out = torch.zeros((n,) + src.shape[1:], dtype=src.dtype)
    return out.index_add_(0, seg, src)

def _pad(x, pw):
    flat = tuple((v for pair in reversed(pw) for v in pair))
    return torch.nn.functional.pad(x, flat)
kernel_name = 'adaLN_cond__gqa_block_cached__swiglu_ffn__decode'

def setup_inputs():

    _w = lambda a: (lambda t: t.to(torch.bfloat16) if t.is_floating_point() else t)(torch.as_tensor(a))

    def _A_setup():
        B, Sq, D = (1, 1, 640)
        Hq, Hkv, Sk, Dh = (32, 32, 8192, 128)
        assert Hq % Hkv == 0, (Hq, Hkv)
        return {'x': _w((lambda *s: torch.randn(*s, dtype=torch.bfloat16) * 0.05)(B, Sq, D)), 'k_cache': _w((lambda *s: torch.randn(*s, dtype=torch.bfloat16) * 3.2)(B, Hkv, Sk, Dh)), 'v_cache': _w((lambda *s: torch.randn(*s, dtype=torch.bfloat16) * 0.4)(B, Hkv, Sk, Dh)), 'wq': _w((lambda *s: torch.randn(*s, dtype=torch.bfloat16) * 3.2)(D, Hq * Dh) * D ** (-0.5)), 'wo': _w((lambda *s: torch.randn(*s, dtype=torch.bfloat16) * 0.4)(Hq * Dh, D) * (Hq * Dh) ** (-0.5))}
    _A_in = _A_setup()

    def _B_setup():
        B, S, D, F = (1, 1, 640, 1728)
        return {'x': _w((lambda *s: torch.randn(*s, dtype=torch.bfloat16) * 0.05)(B, S, D)), 'w_gate': _w((lambda *s: torch.randn(*s, dtype=torch.bfloat16) * 0.05)(D, F)), 'w_up': _w((lambda *s: torch.randn(*s, dtype=torch.bfloat16) * 0.05)(D, F)), 'w_down': _w((lambda *s: torch.randn(*s, dtype=torch.bfloat16) * 0.05)(F, D))}
    _B_in = _B_setup()
    return {'A_x': _A_in['x'], 'A_k_cache': _A_in['k_cache'], 'A_v_cache': _A_in['v_cache'], 'A_wq': _A_in['wq'], 'A_wo': _A_in['wo'], 'B_x': _B_in['x'], 'B_w_gate': _B_in['w_gate'], 'B_w_up': _B_in['w_up'], 'B_w_down': _B_in['w_down'], 'c': _w((lambda *s: torch.randn(*s, dtype=torch.bfloat16) * 0.1)(1, 640) * 8.0), 'w_mod': _w((lambda *s: torch.randn(*s, dtype=torch.bfloat16) * 0.1)(640, 6 * 640) * 640 ** (-0.5) * 8.0)}

def reference(A_x, A_k_cache, A_v_cache, A_wq, A_wo, B_x, B_w_gate, B_w_up, B_w_down, c, w_mod):

    def _A_ref(x, k_cache, v_cache, wq, wo):
        B, Sq, D = x.shape
        Hq, Dh = (32, 128)
        Hkv = k_cache.shape[1]
        rep = Hq // Hkv
        q = (lambda x, *d: x.permute(*d))((x @ wq).reshape(B, Sq, Hq, Dh), 0, 2, 1, 3)
        k = (lambda x, n, axis: torch.repeat_interleave(x, n, dim=axis))(k_cache, rep, axis=1)
        v = (lambda x, n, axis: torch.repeat_interleave(x, n, dim=axis))(v_cache, rep, axis=1)
        scores = torch.einsum('bhqd,bhkd->bhqk', q, k) * Dh ** (-0.5)
        p = _softmax(scores, axis=-1)
        o = torch.einsum('bhqk,bhkd->bhqd', p, v)
        return (lambda x, *d: x.permute(*d))(o, 0, 2, 1, 3).reshape(B, Sq, Hq * Dh) @ wo

    def _B_ref(x, w_gate, w_up, w_down):
        g = _silu(x @ w_gate)
        u = x @ w_up
        return g * u @ w_down
    x = A_x
    mod = (_silu(c) @ w_mod).reshape(c.shape[0], 6, 1, -1)
    sa, ca, ga, sb, cb, gb = (mod[:, 0].clone(), mod[:, 1].clone(), mod[:, 2].clone(), mod[:, 3].clone(), mod[:, 4].clone(), mod[:, 5].clone())
    h = _layernorm(x, axis=-1) * (1 + ca) + sa
    x = x + ga * _A_ref(h, A_k_cache, A_v_cache, A_wq, A_wo)
    h = _layernorm(x, axis=-1) * (1 + cb) + sb
    x = x + gb * _B_ref(h, B_w_gate, B_w_up, B_w_down)
    return x
```

```asm
; @launch grid=(256,1,1) block=(768,1,1) lds=163456
.amdgcn_target "amdgcn-amd-amdhsa--gfx950"
.text
.globl adaLN_cond__gqa_block_cached__swiglu_ffn__decode_kernel
.p2align 8
.type adaLN_cond__gqa_block_cached__swiglu_ffn__decode_kernel,@function
adaLN_cond__gqa_block_cached__swiglu_ffn__decode_kernel:
    s_load_dwordx16 s[16:31], s[0:1], 0
    s_load_dwordx8 s[32:39], s[0:1], 64
    s_load_dwordx2 s[42:43], s[0:1], 104
    v_lshrrev_b32 v2, 6, v0
    v_and_b32 v1, 63, v0
    v_readfirstlane_b32 s3, v2
    s_cmp_ge_u32 s2, 256
    s_nop 2
    s_cbranch_scc1 L_end
    s_and_b32 s6, s2, 7
    s_lshl_b32 s6, s6, 5
    s_lshr_b32 s11, s2, 3
    s_or_b32 s6, s6, s11
    s_cmp_lt_u32 s3, 4
    s_cbranch_scc1 L_help
    s_sub_u32 s10, s3, 4
    s_lshl_b32 s9, s6, 18
    s_lshl_b32 s14, s10, 12
    v_lshl_add_u32 v1, v1, 4, s9
    s_mov_b32 s46, 0x4000000
    s_mov_b32 s47, 0x20000
    s_waitcnt lgkmcnt(0)
    s_mov_b32 s44, s18
    s_and_b32 s45, s19, 0xffff
    buffer_load_dwordx4 v[40:43], v1, s[44:47], s14 offen offset:0 nt
    buffer_load_dwordx4 v[44:47], v1, s[44:47], s14 offen offset:1024 nt
    buffer_load_dwordx4 v[48:51], v1, s[44:47], s14 offen offset:2048 nt
    buffer_load_dwordx4 v[52:55], v1, s[44:47], s14 offen offset:3072 nt
    s_barrier
    s_mov_b32 s48, s20
    s_and_b32 s49, s21, 0xffff
    s_mov_b32 s50, 67108864
    s_mov_b32 s51, 0x20000
    s_xor_b32 s15, s14, 8192
    s_mul_i32 s13, s10, 18432
    s_add_u32 s13, s13, 16000
    s_load_dword s7, s[42:43], 0
    s_getpc_b64 s[72:73]
L_pc_1:
    s_lshl_b32 s11, s2, 2
    s_add_u32 s11, s11, role_tbl-L_pc_1
    s_load_dword s26, s[72:73], s11
    s_mov_b32 s52, s42
    s_and_b32 s53, s43, 0xffff
    s_mov_b32 s54, 786432
    s_mov_b32 s55, 0x20000
    s_mov_b32 s8, 400000
    s_mov_b32 s74, 0x05040100
    s_mov_b32 s75, 0x07060302
    s_mov_b32 s76, 0xffff0000
    s_mov_b64 s[62:63], -1
    v_and_b32 v23, 15, v0
    v_mov_b32 v24, 0xffff
    v_mov_b32 v25, 0xffff0000
    v_cmp_eq_u32 vcc, 0, v23
    s_nop 1
    v_cndmask_b32 v6, 0, v24, vcc
    v_cmp_eq_u32 vcc, 1, v23
    s_nop 1
    v_cndmask_b32 v6, v6, v25, vcc
    v_cmp_eq_u32 vcc, 2, v23
    s_nop 1
    v_cndmask_b32 v7, 0, v24, vcc
    v_cmp_eq_u32 vcc, 3, v23
    s_nop 1
    v_cndmask_b32 v7, v7, v25, vcc
    v_cmp_eq_u32 vcc, 4, v23
    s_nop 1
    v_cndmask_b32 v8, 0, v24, vcc
    v_cmp_eq_u32 vcc, 5, v23
    s_nop 1
    v_cndmask_b32 v8, v8, v25, vcc
    v_cmp_eq_u32 vcc, 6, v23
    s_nop 1
    v_cndmask_b32 v9, 0, v24, vcc
    v_cmp_eq_u32 vcc, 7, v23
    s_nop 1
    v_cndmask_b32 v9, v9, v25, vcc
    v_mov_b32 v18, 0
    v_mov_b32 v19, 0
    v_mov_b32 v20, 0
    v_mov_b32 v21, 0
    v_lshlrev_b32 v23, 4, v23
    v_and_b32 v29, 63, v0
    v_lshl_add_u32 v29, v29, 4, s13
    s_waitcnt vmcnt(3)
    s_xor_b32 s12, s15, 32768
    buffer_load_dwordx4 v[56:59], v1, s[44:47], s12 offen offset:0 nt
    s_waitcnt vmcnt(3)
    buffer_load_dwordx4 v[60:63], v1, s[44:47], s12 offen offset:1024 nt
    s_waitcnt vmcnt(3)
    buffer_load_dwordx4 v[64:67], v1, s[44:47], s12 offen offset:2048 nt
    s_waitcnt vmcnt(3)
    buffer_load_dwordx4 v[68:71], v1, s[44:47], s12 offen offset:3072 nt
    s_waitcnt vmcnt(3)
    s_xor_b32 s12, s14, 65536
    buffer_load_dwordx4 v[72:75], v1, s[44:47], s12 offen offset:0 nt
    s_waitcnt vmcnt(3)
    buffer_load_dwordx4 v[76:79], v1, s[44:47], s12 offen offset:1024 nt
    s_waitcnt vmcnt(3)
    buffer_load_dwordx4 v[80:83], v1, s[44:47], s12 offen offset:2048 nt
    s_waitcnt vmcnt(3)
    buffer_load_dwordx4 v[84:87], v1, s[44:47], s12 offen offset:3072 nt
    s_waitcnt vmcnt(3)
    s_xor_b32 s12, s15, 98304
    buffer_load_dwordx4 v[88:91], v1, s[44:47], s12 offen offset:0 nt
    s_waitcnt vmcnt(3)
    buffer_load_dwordx4 v[92:95], v1, s[44:47], s12 offen offset:1024 nt
    s_waitcnt vmcnt(3)
    buffer_load_dwordx4 v[96:99], v1, s[44:47], s12 offen offset:2048 nt
    s_waitcnt vmcnt(3)
    buffer_load_dwordx4 v[100:103], v1, s[44:47], s12 offen offset:3072 nt
    s_waitcnt vmcnt(3)
    s_xor_b32 s12, s14, 131072
    buffer_load_dwordx4 v[104:107], v1, s[44:47], s12 offen offset:0 nt
    s_waitcnt vmcnt(3)
    buffer_load_dwordx4 v[108:111], v1, s[44:47], s12 offen offset:1024 nt
    s_waitcnt vmcnt(3)
    buffer_load_dwordx4 v[112:115], v1, s[44:47], s12 offen offset:2048 nt
    s_waitcnt vmcnt(3)
    buffer_load_dwordx4 v[116:119], v1, s[44:47], s12 offen offset:3072 nt
    s_waitcnt vmcnt(3)
    s_xor_b32 s12, s15, 163840
    buffer_load_dwordx4 v[120:123], v1, s[44:47], s12 offen offset:0 nt
    s_waitcnt vmcnt(3)
    buffer_load_dwordx4 v[124:127], v1, s[44:47], s12 offen offset:1024 nt
    s_waitcnt vmcnt(3)
    buffer_load_dwordx4 v[128:131], v1, s[44:47], s12 offen offset:2048 nt
    s_waitcnt vmcnt(3)
    buffer_load_dwordx4 v[132:135], v1, s[44:47], s12 offen offset:3072 nt
    s_waitcnt vmcnt(3)
    s_xor_b32 s12, s14, 196608
    buffer_load_dwordx4 v[136:139], v1, s[44:47], s12 offen offset:0 nt
    s_waitcnt vmcnt(3)
    buffer_load_dwordx4 v[140:143], v1, s[44:47], s12 offen offset:1024 nt
    s_waitcnt vmcnt(3)
    buffer_load_dwordx4 v[144:147], v1, s[44:47], s12 offen offset:2048 nt
    s_waitcnt vmcnt(3)
    buffer_load_dwordx4 v[148:151], v1, s[44:47], s12 offen offset:3072 nt
    s_waitcnt vmcnt(3)
    s_xor_b32 s12, s15, 229376
    buffer_load_dwordx4 v[152:155], v1, s[44:47], s12 offen offset:0 nt
    s_waitcnt vmcnt(3)
    buffer_load_dwordx4 v[156:159], v1, s[44:47], s12 offen offset:1024 nt
    s_waitcnt vmcnt(3)
    buffer_load_dwordx4 v[160:163], v1, s[44:47], s12 offen offset:2048 nt
    s_waitcnt vmcnt(3)
    buffer_load_dwordx4 v[164:167], v1, s[44:47], s12 offen offset:3072 nt
    s_waitcnt vmcnt(3)
    s_xor_b32 s12, s14, 0
    s_add_u32 m0, s13, 0
    s_nop 0
    buffer_load_dwordx4 v1, s[48:51], s12 offen offset:0 nt lds
    s_waitcnt vmcnt(3)
    buffer_load_dwordx4 v1, s[48:51], s12 offen offset:1024 nt lds
    s_waitcnt vmcnt(3)
    buffer_load_dwordx4 v1, s[48:51], s12 offen offset:2048 nt lds
    s_waitcnt vmcnt(3)
    buffer_load_dwordx4 v1, s[48:51], s12 offen offset:3072 nt lds
    s_waitcnt vmcnt(3)
    s_xor_b32 s12, s15, 32768
    s_add_u32 m0, s13, 4096
    s_nop 0
    buffer_load_dwordx4 v1, s[48:51], s12 offen offset:0 nt lds
    s_waitcnt vmcnt(3)
    buffer_load_dwordx4 v1, s[48:51], s12 offen offset:1024 nt lds
    s_waitcnt vmcnt(3)
    buffer_load_dwordx4 v1, s[48:51], s12 offen offset:2048 nt lds
    s_waitcnt vmcnt(3)
    buffer_load_dwordx4 v1, s[48:51], s12 offen offset:3072 nt lds
    s_waitcnt vmcnt(3)
    s_xor_b32 s12, s14, 65536
    s_add_u32 m0, s13, 8192
    s_nop 0
    buffer_load_dwordx4 v1, s[48:51], s12 offen offset:0 nt lds
    s_waitcnt vmcnt(3)
    buffer_load_dwordx4 v1, s[48:51], s12 offen offset:1024 nt lds
    s_waitcnt vmcnt(3)
    buffer_load_dwordx4 v1, s[48:51], s12 offen offset:2048 nt lds
    s_waitcnt vmcnt(3)
    buffer_load_dwordx4 v1, s[48:51], s12 offen offset:3072 nt lds
    s_waitcnt vmcnt(3)
    s_xor_b32 s12, s15, 98304
    s_add_u32 m0, s13, 12288
    s_nop 0
    buffer_load_dwordx4 v1, s[48:51], s12 offen offset:0 nt lds
    s_waitcnt vmcnt(3)
    buffer_load_dwordx4 v1, s[48:51], s12 offen offset:1024 nt lds
    s_waitcnt vmcnt(3)
    buffer_load_dwordx4 v1, s[48:51], s12 offen offset:2048 nt lds
    s_waitcnt vmcnt(3)
    buffer_load_dwordx4 v1, s[48:51], s12 offen offset:3072 nt lds
    s_waitcnt vmcnt(3)
    s_xor_b32 s12, s14, 131072
    s_add_u32 m0, s13, 16384
    s_nop 0
    buffer_load_dwordx4 v1, s[48:51], s12 offen offset:0 nt lds
    s_waitcnt vmcnt(3)
    buffer_load_dwordx4 v1, s[48:51], s12 offen offset:1024 nt lds
    s_mov_b64 s[72:73], exec
L_poll_2:
    ds_read_b128 v[2:5], v23 offset:0
    s_waitcnt lgkmcnt(0)
    v_max3_u32 v24, v2, v3, v4
    v_max_u32 v24, v24, v5
    v_cmp_eq_u32 vcc, -1, v24
    s_nop 0
    s_cbranch_vccz L_pdone_3
    s_cmp_eq_u32 s8, 0
    s_cbranch_scc1 L_pdone_3
    s_sub_u32 s8, s8, 1
    s_mov_b64 exec, vcc
    s_sleep 2
    s_branch L_poll_2
L_pdone_3:
    s_mov_b64 exec, s[72:73]
    v_dot2_f32_bf16 v22, v40, v2, 0
    v_dot2_f32_bf16 v23, v44, v2, 0
    v_dot2_f32_bf16 v24, v48, v2, 0
    v_dot2_f32_bf16 v25, v52, v2, 0
    v_dot2_f32_bf16 v22, v41, v3, v22
    v_dot2_f32_bf16 v23, v45, v3, v23
    v_dot2_f32_bf16 v24, v49, v3, v24
    v_dot2_f32_bf16 v25, v53, v3, v25
    v_dot2_f32_bf16 v22, v42, v4, v22
    v_dot2_f32_bf16 v23, v46, v4, v23
    v_dot2_f32_bf16 v24, v50, v4, v24
    v_dot2_f32_bf16 v25, v54, v4, v25
    v_dot2_f32_bf16 v22, v43, v5, v22
    v_dot2_f32_bf16 v23, v47, v5, v23
    v_dot2_f32_bf16 v24, v51, v5, v24
    v_dot2_f32_bf16 v25, v55, v5, v25
    v_add_f32_dpp v26, v22, v22 row_ror:8 row_mask:0xf bank_mask:0x3
    v_add_f32_dpp v27, v23, v23 row_ror:8 row_mask:0xf bank_mask:0x3
    s_nop 0
    v_add_f32_dpp v26, v24, v24 row_ror:8 row_mask:0xf bank_mask:0xc
    v_add_f32_dpp v27, v25, v25 row_ror:8 row_mask:0xf bank_mask:0xc
    s_nop 0
    v_add_f32_dpp v31, v26, v26 row_shl:4 row_mask:0xf bank_mask:0x5
    s_nop 1
    v_add_f32_dpp v31, v27, v27 row_shr:4 row_mask:0xf bank_mask:0xa
    v_dot2_f32_bf16 v22, v56, v2, 0
    v_dot2_f32_bf16 v23, v60, v2, 0
    v_dot2_f32_bf16 v24, v64, v2, 0
    v_dot2_f32_bf16 v25, v68, v2, 0
    v_dot2_f32_bf16 v22, v57, v3, v22
    v_dot2_f32_bf16 v23, v61, v3, v23
    v_dot2_f32_bf16 v24, v65, v3, v24
    v_dot2_f32_bf16 v25, v69, v3, v25
    v_dot2_f32_bf16 v22, v58, v4, v22
    v_dot2_f32_bf16 v23, v62, v4, v23
    v_dot2_f32_bf16 v24, v66, v4, v24
    v_dot2_f32_bf16 v25, v70, v4, v25
    v_dot2_f32_bf16 v22, v59, v5, v22
    v_dot2_f32_bf16 v23, v63, v5, v23
    v_dot2_f32_bf16 v24, v67, v5, v24
    v_dot2_f32_bf16 v25, v71, v5, v25
    s_waitcnt vmcnt(3)
    buffer_load_dwordx4 v[40:43], v1, s[48:51], s12 offen offset:2048 nt
    v_add_f32_dpp v26, v22, v22 row_ror:8 row_mask:0xf bank_mask:0x3
    v_add_f32_dpp v27, v23, v23 row_ror:8 row_mask:0xf bank_mask:0x3
    s_nop 0
    v_add_f32_dpp v26, v24, v24 row_ror:8 row_mask:0xf bank_mask:0xc
    v_add_f32_dpp v27, v25, v25 row_ror:8 row_mask:0xf bank_mask:0xc
    s_nop 0
    v_add_f32_dpp v32, v26, v26 row_shl:4 row_mask:0xf bank_mask:0x5
    s_nop 1
    v_add_f32_dpp v32, v27, v27 row_shr:4 row_mask:0xf bank_mask:0xa
    v_dot2_f32_bf16 v22, v72, v2, 0
    v_dot2_f32_bf16 v23, v76, v2, 0
    v_dot2_f32_bf16 v24, v80, v2, 0
    v_dot2_f32_bf16 v25, v84, v2, 0
    v_dot2_f32_bf16 v22, v73, v3, v22
    v_dot2_f32_bf16 v23, v77, v3, v23
    v_dot2_f32_bf16 v24, v81, v3, v24
    v_dot2_f32_bf16 v25, v85, v3, v25
    v_dot2_f32_bf16 v22, v74, v4, v22
    v_dot2_f32_bf16 v23, v78, v4, v23
    v_dot2_f32_bf16 v24, v82, v4, v24
    v_dot2_f32_bf16 v25, v86, v4, v25
    v_dot2_f32_bf16 v22, v75, v5, v22
    v_dot2_f32_bf16 v23, v79, v5, v23
    v_dot2_f32_bf16 v24, v83, v5, v24
    v_dot2_f32_bf16 v25, v87, v5, v25
    v_add_f32_dpp v26, v22, v22 row_ror:8 row_mask:0xf bank_mask:0x3
    v_add_f32_dpp v27, v23, v23 row_ror:8 row_mask:0xf bank_mask:0x3
    s_nop 0
    v_add_f32_dpp v26, v24, v24 row_ror:8 row_mask:0xf bank_mask:0xc
    v_add_f32_dpp v27, v25, v25 row_ror:8 row_mask:0xf bank_mask:0xc
    s_nop 0
    v_add_f32_dpp v33, v26, v26 row_shl:4 row_mask:0xf bank_mask:0x5
    s_nop 1
    v_add_f32_dpp v33, v27, v27 row_shr:4 row_mask:0xf bank_mask:0xa
    v_dot2_f32_bf16 v22, v88, v2, 0
    v_dot2_f32_bf16 v23, v92, v2, 0
    v_dot2_f32_bf16 v24, v96, v2, 0
    v_dot2_f32_bf16 v25, v100, v2, 0
    v_dot2_f32_bf16 v22, v89, v3, v22
    v_dot2_f32_bf16 v23, v93, v3, v23
    v_dot2_f32_bf16 v24, v97, v3, v24
    v_dot2_f32_bf16 v25, v101, v3, v25
    v_dot2_f32_bf16 v22, v90, v4, v22
    v_dot2_f32_bf16 v23, v94, v4, v23
    v_dot2_f32_bf16 v24, v98, v4, v24
    v_dot2_f32_bf16 v25, v102, v4, v25
    v_dot2_f32_bf16 v22, v91, v5, v22
    v_dot2_f32_bf16 v23, v95, v5, v23
    v_dot2_f32_bf16 v24, v99, v5, v24
    v_dot2_f32_bf16 v25, v103, v5, v25
    v_add_f32_dpp v26, v22, v22 row_ror:8 row_mask:0xf bank_mask:0x3
    v_add_f32_dpp v27, v23, v23 row_ror:8 row_mask:0xf bank_mask:0x3
    s_nop 0
    v_add_f32_dpp v26, v24, v24 row_ror:8 row_mask:0xf bank_mask:0xc
    v_add_f32_dpp v27, v25, v25 row_ror:8 row_mask:0xf bank_mask:0xc
    s_nop 0
    v_add_f32_dpp v34, v26, v26 row_shl:4 row_mask:0xf bank_mask:0x5
    s_nop 1
    v_add_f32_dpp v34, v27, v27 row_shr:4 row_mask:0xf bank_mask:0xa
    v_dot2_f32_bf16 v22, v104, v2, 0
    v_dot2_f32_bf16 v23, v108, v2, 0
    v_dot2_f32_bf16 v24, v112, v2, 0
    v_dot2_f32_bf16 v25, v116, v2, 0
    v_dot2_f32_bf16 v22, v105, v3, v22
    v_dot2_f32_bf16 v23, v109, v3, v23
    v_dot2_f32_bf16 v24, v113, v3, v24
    v_dot2_f32_bf16 v25, v117, v3, v25
    v_dot2_f32_bf16 v22, v106, v4, v22
    v_dot2_f32_bf16 v23, v110, v4, v23
    v_dot2_f32_bf16 v24, v114, v4, v24
    v_dot2_f32_bf16 v25, v118, v4, v25
    v_dot2_f32_bf16 v22, v107, v5, v22
    v_dot2_f32_bf16 v23, v111, v5, v23
    v_dot2_f32_bf16 v24, v115, v5, v24
    v_dot2_f32_bf16 v25, v119, v5, v25
    s_waitcnt vmcnt(3)
    buffer_load_dwordx4 v[44:47], v1, s[48:51], s12 offen offset:3072 nt
    v_add_f32_dpp v26, v22, v22 row_ror:8 row_mask:0xf bank_mask:0x3
    v_add_f32_dpp v27, v23, v23 row_ror:8 row_mask:0xf bank_mask:0x3
    s_nop 0
    v_add_f32_dpp v26, v24, v24 row_ror:8 row_mask:0xf bank_mask:0xc
    v_add_f32_dpp v27, v25, v25 row_ror:8 row_mask:0xf bank_mask:0xc
    s_nop 0
    v_add_f32_dpp v35, v26, v26 row_shl:4 row_mask:0xf bank_mask:0x5
    s_nop 1
    v_add_f32_dpp v35, v27, v27 row_shr:4 row_mask:0xf bank_mask:0xa
    v_dot2_f32_bf16 v22, v120, v2, 0
    v_dot2_f32_bf16 v23, v124, v2, 0
    v_dot2_f32_bf16 v24, v128, v2, 0
    v_dot2_f32_bf16 v25, v132, v2, 0
    v_dot2_f32_bf16 v22, v121, v3, v22
    v_dot2_f32_bf16 v23, v125, v3, v23
    v_dot2_f32_bf16 v24, v129, v3, v24
    v_dot2_f32_bf16 v25, v133, v3, v25
    v_dot2_f32_bf16 v22, v122, v4, v22
    v_dot2_f32_bf16 v23, v126, v4, v23
    v_dot2_f32_bf16 v24, v130, v4, v24
    v_dot2_f32_bf16 v25, v134, v4, v25
    v_dot2_f32_bf16 v22, v123, v5, v22
    v_dot2_f32_bf16 v23, v127, v5, v23
    v_dot2_f32_bf16 v24, v131, v5, v24
    v_dot2_f32_bf16 v25, v135, v5, v25
    v_add_f32_dpp v26, v22, v22 row_ror:8 row_mask:0xf bank_mask:0x3
    v_add_f32_dpp v27, v23, v23 row_ror:8 row_mask:0xf bank_mask:0x3
    s_nop 0
    v_add_f32_dpp v26, v24, v24 row_ror:8 row_mask:0xf bank_mask:0xc
    v_add_f32_dpp v27, v25, v25 row_ror:8 row_mask:0xf bank_mask:0xc
    s_nop 0
    v_add_f32_dpp v36, v26, v26 row_shl:4 row_mask:0xf bank_mask:0x5
    s_nop 1
    v_add_f32_dpp v36, v27, v27 row_shr:4 row_mask:0xf bank_mask:0xa
    v_dot2_f32_bf16 v22, v136, v2, 0
    v_dot2_f32_bf16 v23, v140, v2, 0
    v_dot2_f32_bf16 v24, v144, v2, 0
    v_dot2_f32_bf16 v25, v148, v2, 0
    v_dot2_f32_bf16 v22, v137, v3, v22
    v_dot2_f32_bf16 v23, v141, v3, v23
    v_dot2_f32_bf16 v24, v145, v3, v24
    v_dot2_f32_bf16 v25, v149, v3, v25
    v_dot2_f32_bf16 v22, v138, v4, v22
    v_dot2_f32_bf16 v23, v142, v4, v23
    v_dot2_f32_bf16 v24, v146, v4, v24
    v_dot2_f32_bf16 v25, v150, v4, v25
    v_dot2_f32_bf16 v22, v139, v5, v22
    v_dot2_f32_bf16 v23, v143, v5, v23
    v_dot2_f32_bf16 v24, v147, v5, v24
    v_dot2_f32_bf16 v25, v151, v5, v25
    v_add_f32_dpp v26, v22, v22 row_ror:8 row_mask:0xf bank_mask:0x3
    v_add_f32_dpp v27, v23, v23 row_ror:8 row_mask:0xf bank_mask:0x3
    s_nop 0
    v_add_f32_dpp v26, v24, v24 row_ror:8 row_mask:0xf bank_mask:0xc
    v_add_f32_dpp v27, v25, v25 row_ror:8 row_mask:0xf bank_mask:0xc
    s_nop 0
    v_add_f32_dpp v37, v26, v26 row_shl:4 row_mask:0xf bank_mask:0x5
    s_nop 1
    v_add_f32_dpp v37, v27, v27 row_shr:4 row_mask:0xf bank_mask:0xa
    v_dot2_f32_bf16 v22, v152, v2, 0
    v_dot2_f32_bf16 v23, v156, v2, 0
    v_dot2_f32_bf16 v24, v160, v2, 0
    v_dot2_f32_bf16 v25, v164, v2, 0
    v_dot2_f32_bf16 v22, v153, v3, v22
    v_dot2_f32_bf16 v23, v157, v3, v23
    v_dot2_f32_bf16 v24, v161, v3, v24
    v_dot2_f32_bf16 v25, v165, v3, v25
    v_dot2_f32_bf16 v22, v154, v4, v22
    v_dot2_f32_bf16 v23, v158, v4, v23
    v_dot2_f32_bf16 v24, v162, v4, v24
    v_dot2_f32_bf16 v25, v166, v4, v25
    v_dot2_f32_bf16 v22, v155, v5, v22
    v_dot2_f32_bf16 v23, v159, v5, v23
    v_dot2_f32_bf16 v24, v163, v5, v24
    v_dot2_f32_bf16 v25, v167, v5, v25
    s_waitcnt vmcnt(3)
    s_xor_b32 s12, s15, 163840
    buffer_load_dwordx4 v[48:51], v1, s[48:51], s12 offen offset:0 nt
    v_add_f32_dpp v26, v22, v22 row_ror:8 row_mask:0xf bank_mask:0x3
    v_add_f32_dpp v27, v23, v23 row_ror:8 row_mask:0xf bank_mask:0x3
    s_nop 0
    v_add_f32_dpp v26, v24, v24 row_ror:8 row_mask:0xf bank_mask:0xc
    v_add_f32_dpp v27, v25, v25 row_ror:8 row_mask:0xf bank_mask:0xc
    s_nop 0
    v_add_f32_dpp v38, v26, v26 row_shl:4 row_mask:0xf bank_mask:0x5
    s_nop 1
    v_add_f32_dpp v38, v27, v27 row_shr:4 row_mask:0xf bank_mask:0xa
    v_add_f32_dpp v31, v31, v31 quad_perm:[2,3,0,1] row_mask:0xf bank_mask:0xf
    v_add_f32_dpp v32, v32, v32 quad_perm:[2,3,0,1] row_mask:0xf bank_mask:0xf
    v_add_f32_dpp v33, v33, v33 quad_perm:[2,3,0,1] row_mask:0xf bank_mask:0xf
    v_add_f32_dpp v34, v34, v34 quad_perm:[2,3,0,1] row_mask:0xf bank_mask:0xf
    v_add_f32_dpp v35, v35, v35 quad_perm:[2,3,0,1] row_mask:0xf bank_mask:0xf
    v_add_f32_dpp v36, v36, v36 quad_perm:[2,3,0,1] row_mask:0xf bank_mask:0xf
    v_add_f32_dpp v37, v37, v37 quad_perm:[2,3,0,1] row_mask:0xf bank_mask:0xf
    v_add_f32_dpp v38, v38, v38 quad_perm:[2,3,0,1] row_mask:0xf bank_mask:0xf
    v_add_f32_dpp v31, v31, v31 quad_perm:[1,0,3,2] row_mask:0xf bank_mask:0xf
    v_add_f32_dpp v32, v32, v32 quad_perm:[1,0,3,2] row_mask:0xf bank_mask:0xf
    v_add_f32_dpp v33, v33, v33 quad_perm:[1,0,3,2] row_mask:0xf bank_mask:0xf
    v_add_f32_dpp v34, v34, v34 quad_perm:[1,0,3,2] row_mask:0xf bank_mask:0xf
    v_add_f32_dpp v35, v35, v35 quad_perm:[1,0,3,2] row_mask:0xf bank_mask:0xf
    v_add_f32_dpp v36, v36, v36 quad_perm:[1,0,3,2] row_mask:0xf bank_mask:0xf
    v_add_f32_dpp v37, v37, v37 quad_perm:[1,0,3,2] row_mask:0xf bank_mask:0xf
    v_add_f32_dpp v38, v38, v38 quad_perm:[1,0,3,2] row_mask:0xf bank_mask:0xf
    v_cvt_pk_bf16_f32 v22, v31, v32
    v_cvt_pk_bf16_f32 v23, v33, v34
    v_cvt_pk_bf16_f32 v24, v35, v36
    v_cvt_pk_bf16_f32 v25, v37, v38
    v_lshlrev_b32 v31, 16, v22
    v_and_b32 v32, s76, v22
    v_lshlrev_b32 v33, 16, v23
    v_and_b32 v34, s76, v23
    v_lshlrev_b32 v35, 16, v24
    v_and_b32 v36, s76, v24
    v_lshlrev_b32 v37, 16, v25
    v_and_b32 v38, s76, v25
    v_mul_f32 v31, 0x3db504f3, v31
    v_mul_f32 v32, 0x3db504f3, v32
    v_mul_f32 v33, 0x3db504f3, v33
    v_mul_f32 v34, 0x3db504f3, v34
    v_mul_f32 v35, 0x3db504f3, v35
    v_mul_f32 v36, 0x3db504f3, v36
    v_mul_f32 v37, 0x3db504f3, v37
    v_mul_f32 v38, 0x3db504f3, v38
    v_cvt_pk_bf16_f32 v22, v31, v32
    v_cvt_pk_bf16_f32 v23, v33, v34
    v_cvt_pk_bf16_f32 v24, v35, v36
    v_cvt_pk_bf16_f32 v25, v37, v38
    v_lshlrev_b32 v31, 16, v22
    v_and_b32 v32, s76, v22
    v_lshlrev_b32 v33, 16, v23
    v_and_b32 v34, s76, v23
    v_lshlrev_b32 v35, 16, v24
    v_and_b32 v36, s76, v24
    v_lshlrev_b32 v37, 16, v25
    v_and_b32 v38, s76, v25
    v_max3_f32 v26, v31, v32, v33
    v_max3_f32 v26, v26, v34, v35
    v_max3_f32 v26, v26, v36, v37
    v_max_f32 v26, v26, v38
    s_nop 1
    v_max_f32_dpp v26, v26, v26 row_ror:4 row_mask:0xf bank_mask:0xf
    s_nop 1
    v_max_f32_dpp v26, v26, v26 row_ror:8 row_mask:0xf bank_mask:0xf
    v_mov_b32 v22, v26
    s_nop 1
    v_permlane16_swap_b32 v22, v26
    v_max_f32 v26, v26, v22
    v_mov_b32 v22, v26
    s_nop 1
    v_permlane32_swap_b32 v22, v26
    v_max_f32 v26, v26, v22
    s_waitcnt vmcnt(3)
    buffer_load_dwordx4 v[52:55], v1, s[48:51], s12 offen offset:1024 nt
    v_sub_f32 v31, v31, v26
    v_sub_f32 v32, v32, v26
    v_sub_f32 v33, v33, v26
    v_sub_f32 v34, v34, v26
    v_sub_f32 v35, v35, v26
    v_sub_f32 v36, v36, v26
    v_sub_f32 v37, v37, v26
    v_sub_f32 v38, v38, v26
    v_mul_f32 v31, 0x3fb8aa3b, v31
    v_mul_f32 v32, 0x3fb8aa3b, v32
    v_mul_f32 v33, 0x3fb8aa3b, v33
    v_mul_f32 v34, 0x3fb8aa3b, v34
    v_mul_f32 v35, 0x3fb8aa3b, v35
    v_mul_f32 v36, 0x3fb8aa3b, v36
    v_mul_f32 v37, 0x3fb8aa3b, v37
    v_mul_f32 v38, 0x3fb8aa3b, v38
    v_exp_f32 v31, v31
    v_exp_f32 v32, v32
    v_exp_f32 v33, v33
    v_exp_f32 v34, v34
    v_exp_f32 v35, v35
    v_exp_f32 v36, v36
    v_exp_f32 v37, v37
    v_exp_f32 v38, v38
    v_add_f32 v27, v31, v32
    v_add_f32 v27, v27, v33
    v_add_f32 v27, v27, v34
    v_add_f32 v27, v27, v35
    v_add_f32 v27, v27, v36
    v_add_f32 v27, v27, v37
    v_add_f32 v27, v27, v38
    v_cvt_pk_bf16_f32 v31, v31, v31
    v_cvt_pk_bf16_f32 v32, v32, v32
    v_cvt_pk_bf16_f32 v33, v33, v33
    v_cvt_pk_bf16_f32 v34, v34, v34
    v_cvt_pk_bf16_f32 v35, v35, v35
    v_cvt_pk_bf16_f32 v36, v36, v36
    v_cvt_pk_bf16_f32 v37, v37, v37
    v_cvt_pk_bf16_f32 v38, v38, v38
    v_add_f32_dpp v27, v27, v27 row_ror:4 row_mask:0xf bank_mask:0xf
    s_nop 1
    v_add_f32_dpp v27, v27, v27 row_ror:8 row_mask:0xf bank_mask:0xf
    v_mov_b32 v22, v27
    s_nop 1
    v_permlane16_swap_b32 v22, v27
    v_add_f32 v27, v27, v22
    v_mov_b32 v22, v27
    s_nop 1
    v_permlane32_swap_b32 v22, v27
    v_add_f32 v27, v27, v22
    v_min_u32 v26, 0xfffffffe, v26
    s_lshl_b32 s11, s10, 3
    v_mov_b32 v22, s11
    s_mov_b64 exec, 1
    ds_write_b64 v22, v[26:27] offset:256
    s_mov_b64 exec, -1
    v_and_b32 v22, 15, v0
    v_lshlrev_b32 v22, 5, v22
    v_and_b32 v23, 16, v0
    v_add_u32 v22, v22, v23
    s_lshl_b32 s11, s10, 9
    v_add_u32 v22, s11, v22
    s_waitcnt lgkmcnt(0)
    ds_read_b128 v[136:139], v29 offset:0
    ds_read_b128 v[140:143], v29 offset:1024
    ds_read_b128 v[144:147], v29 offset:2048
    ds_read_b128 v[148:151], v29 offset:3072
    v_and_b32_dpp v10, v31, v6 row_newbcast:0 row_mask:0xf bank_mask:0xf
    v_and_b32_dpp v11, v31, v7 row_newbcast:0 row_mask:0xf bank_mask:0xf
    v_and_b32_dpp v12, v31, v8 row_newbcast:0 row_mask:0xf bank_mask:0xf
    v_and_b32_dpp v13, v31, v9 row_newbcast:0 row_mask:0xf bank_mask:0xf
    s_waitcnt lgkmcnt(0)
    ds_read_b128 v[152:155], v29 offset:4096
    ds_read_b128 v[156:159], v29 offset:5120
    ds_read_b128 v[160:163], v29 offset:6144
    ds_read_b128 v[164:167], v29 offset:7168
    v_mfma_f32_16x16x32_bf16 v[18:21], v[10:13], v[136:139], v[18:21]
    v_and_b32_dpp v14, v31, v6 row_newbcast:4 row_mask:0xf bank_mask:0xf
    v_and_b32_dpp v15, v31, v7 row_newbcast:4 row_mask:0xf bank_mask:0xf
    v_and_b32_dpp v16, v31, v8 row_newbcast:4 row_mask:0xf bank_mask:0xf
    v_and_b32_dpp v17, v31, v9 row_newbcast:4 row_mask:0xf bank_mask:0xf
    s_nop 1
    v_mfma_f32_16x16x32_bf16 v[18:21], v[14:17], v[140:143], v[18:21]
    v_and_b32_dpp v10, v31, v6 row_newbcast:8 row_mask:0xf bank_mask:0xf
    v_and_b32_dpp v11, v31, v7 row_newbcast:8 row_mask:0xf bank_mask:0xf
    v_and_b32_dpp v12, v31, v8 row_newbcast:8 row_mask:0xf bank_mask:0xf
    v_and_b32_dpp v13, v31, v9 row_newbcast:8 row_mask:0xf bank_mask:0xf
    s_nop 1
    v_mfma_f32_16x16x32_bf16 v[18:21], v[10:13], v[144:147], v[18:21]
    v_and_b32_dpp v14, v31, v6 row_newbcast:12 row_mask:0xf bank_mask:0xf
    v_and_b32_dpp v15, v31, v7 row_newbcast:12 row_mask:0xf bank_mask:0xf
    v_and_b32_dpp v16, v31, v8 row_newbcast:12 row_mask:0xf bank_mask:0xf
    v_and_b32_dpp v17, v31, v9 row_newbcast:12 row_mask:0xf bank_mask:0xf
    s_nop 1
    v_mfma_f32_16x16x32_bf16 v[18:21], v[14:17], v[148:151], v[18:21]
    v_and_b32_dpp v10, v32, v6 row_newbcast:0 row_mask:0xf bank_mask:0xf
    v_and_b32_dpp v11, v32, v7 row_newbcast:0 row_mask:0xf bank_mask:0xf
    v_and_b32_dpp v12, v32, v8 row_newbcast:0 row_mask:0xf bank_mask:0xf
    v_and_b32_dpp v13, v32, v9 row_newbcast:0 row_mask:0xf bank_mask:0xf
    s_waitcnt vmcnt(3)
    buffer_load_dwordx4 v[56:59], v1, s[48:51], s12 offen offset:2048 nt
    s_waitcnt lgkmcnt(0)
    ds_read_b128 v[136:139], v29 offset:8192
    ds_read_b128 v[140:143], v29 offset:9216
    ds_read_b128 v[144:147], v29 offset:10240
    ds_read_b128 v[148:151], v29 offset:11264
    v_mfma_f32_16x16x32_bf16 v[18:21], v[10:13], v[152:155], v[18:21]
    v_and_b32_dpp v14, v32, v6 row_newbcast:4 row_mask:0xf bank_mask:0xf
    v_and_b32_dpp v15, v32, v7 row_newbcast:4 row_mask:0xf bank_mask:0xf
    v_and_b32_dpp v16, v32, v8 row_newbcast:4 row_mask:0xf bank_mask:0xf
    v_and_b32_dpp v17, v32, v9 row_newbcast:4 row_mask:0xf bank_mask:0xf
    s_nop 1
    v_mfma_f32_16x16x32_bf16 v[18:21], v[14:17], v[156:159], v[18:21]
    v_and_b32_dpp v10, v32, v6 row_newbcast:8 row_mask:0xf bank_mask:0xf
    v_and_b32_dpp v11, v32, v7 row_newbcast:8 row_mask:0xf bank_mask:0xf
    v_and_b32_dpp v12, v32, v8 row_newbcast:8 row_mask:0xf bank_mask:0xf
    v_and_b32_dpp v13, v32, v9 row_newbcast:8 row_mask:0xf bank_mask:0xf
    s_nop 1
    v_mfma_f32_16x16x32_bf16 v[18:21], v[10:13], v[160:163], v[18:21]
    v_and_b32_dpp v14, v32, v6 row_newbcast:12 row_mask:0xf bank_mask:0xf
    v_and_b32_dpp v15, v32, v7 row_newbcast:12 row_mask:0xf bank_mask:0xf
    v_and_b32_dpp v16, v32, v8 row_newbcast:12 row_mask:0xf bank_mask:0xf
    v_and_b32_dpp v17, v32, v9 row_newbcast:12 row_mask:0xf bank_mask:0xf
    s_nop 1
    v_mfma_f32_16x16x32_bf16 v[18:21], v[14:17], v[164:167], v[18:21]
    v_and_b32_dpp v10, v33, v6 row_newbcast:0 row_mask:0xf bank_mask:0xf
    v_and_b32_dpp v11, v33, v7 row_newbcast:0 row_mask:0xf bank_mask:0xf
    v_and_b32_dpp v12, v33, v8 row_newbcast:0 row_mask:0xf bank_mask:0xf
    v_and_b32_dpp v13, v33, v9 row_newbcast:0 row_mask:0xf bank_mask:0xf
    s_waitcnt lgkmcnt(0)
    ds_read_b128 v[152:155], v29 offset:12288
    ds_read_b128 v[156:159], v29 offset:13312
    ds_read_b128 v[160:163], v29 offset:14336
    ds_read_b128 v[164:167], v29 offset:15360
    v_mfma_f32_16x16x32_bf16 v[18:21], v[10:13], v[136:139], v[18:21]
    v_and_b32_dpp v14, v33, v6 row_newbcast:4 row_mask:0xf bank_mask:0xf
    v_and_b32_dpp v15, v33, v7 row_newbcast:4 row_mask:0xf bank_mask:0xf
    v_and_b32_dpp v16, v33, v8 row_newbcast:4 row_mask:0xf bank_mask:0xf
    v_and_b32_dpp v17, v33, v9 row_newbcast:4 row_mask:0xf bank_mask:0xf
    s_nop 1
    v_mfma_f32_16x16x32_bf16 v[18:21], v[14:17], v[140:143], v[18:21]
    v_and_b32_dpp v10, v33, v6 row_newbcast:8 row_mask:0xf bank_mask:0xf
    v_and_b32_dpp v11, v33, v7 row_newbcast:8 row_mask:0xf bank_mask:0xf
    v_and_b32_dpp v12, v33, v8 row_newbcast:8 row_mask:0xf bank_mask:0xf
    v_and_b32_dpp v13, v33, v9 row_newbcast:8 row_mask:0xf bank_mask:0xf
    s_nop 1
    v_mfma_f32_16x16x32_bf16 v[18:21], v[10:13], v[144:147], v[18:21]
    v_and_b32_dpp v14, v33, v6 row_newbcast:12 row_mask:0xf bank_mask:0xf
    v_and_b32_dpp v15, v33, v7 row_newbcast:12 row_mask:0xf bank_mask:0xf
    v_and_b32_dpp v16, v33, v8 row_newbcast:12 row_mask:0xf bank_mask:0xf
    v_and_b32_dpp v17, v33, v9 row_newbcast:12 row_mask:0xf bank_mask:0xf
    s_nop 1
    v_mfma_f32_16x16x32_bf16 v[18:21], v[14:17], v[148:151], v[18:21]
    v_and_b32_dpp v10, v34, v6 row_newbcast:0 row_mask:0xf bank_mask:0xf
    v_and_b32_dpp v11, v34, v7 row_newbcast:0 row_mask:0xf bank_mask:0xf
    v_and_b32_dpp v12, v34, v8 row_newbcast:0 row_mask:0xf bank_mask:0xf
    v_and_b32_dpp v13, v34, v9 row_newbcast:0 row_mask:0xf bank_mask:0xf
    s_waitcnt vmcnt(3)
    buffer_load_dwordx4 v[60:63], v1, s[48:51], s12 offen offset:3072 nt
    s_waitcnt lgkmcnt(0)
    ds_read_b128 v[136:139], v29 offset:16384
    ds_read_b128 v[140:143], v29 offset:17408
    v_mfma_f32_16x16x32_bf16 v[18:21], v[10:13], v[152:155], v[18:21]
    v_and_b32_dpp v14, v34, v6 row_newbcast:4 row_mask:0xf bank_mask:0xf
    v_and_b32_dpp v15, v34, v7 row_newbcast:4 row_mask:0xf bank_mask:0xf
    v_and_b32_dpp v16, v34, v8 row_newbcast:4 row_mask:0xf bank_mask:0xf
    v_and_b32_dpp v17, v34, v9 row_newbcast:4 row_mask:0xf bank_mask:0xf
    s_nop 1
    v_mfma_f32_16x16x32_bf16 v[18:21], v[14:17], v[156:159], v[18:21]
    v_and_b32_dpp v10, v34, v6 row_newbcast:8 row_mask:0xf bank_mask:0xf
    v_and_b32_dpp v11, v34, v7 row_newbcast:8 row_mask:0xf bank_mask:0xf
    v_and_b32_dpp v12, v34, v8 row_newbcast:8 row_mask:0xf bank_mask:0xf
    v_and_b32_dpp v13, v34, v9 row_newbcast:8 row_mask:0xf bank_mask:0xf
    s_nop 1
    v_mfma_f32_16x16x32_bf16 v[18:21], v[10:13], v[160:163], v[18:21]
    v_and_b32_dpp v14, v34, v6 row_newbcast:12 row_mask:0xf bank_mask:0xf
    v_and_b32_dpp v15, v34, v7 row_newbcast:12 row_mask:0xf bank_mask:0xf
    v_and_b32_dpp v16, v34, v8 row_newbcast:12 row_mask:0xf bank_mask:0xf
    v_and_b32_dpp v17, v34, v9 row_newbcast:12 row_mask:0xf bank_mask:0xf
    s_nop 1
    v_mfma_f32_16x16x32_bf16 v[18:21], v[14:17], v[164:167], v[18:21]
    v_and_b32_dpp v10, v35, v6 row_newbcast:0 row_mask:0xf bank_mask:0xf
    v_and_b32_dpp v11, v35, v7 row_newbcast:0 row_mask:0xf bank_mask:0xf
    v_and_b32_dpp v12, v35, v8 row_newbcast:0 row_mask:0xf bank_mask:0xf
    v_and_b32_dpp v13, v35, v9 row_newbcast:0 row_mask:0xf bank_mask:0xf
    s_waitcnt lgkmcnt(0)
    s_nop 0
    v_mfma_f32_16x16x32_bf16 v[18:21], v[10:13], v[136:139], v[18:21]
    v_and_b32_dpp v14, v35, v6 row_newbcast:4 row_mask:0xf bank_mask:0xf
    v_and_b32_dpp v15, v35, v7 row_newbcast:4 row_mask:0xf bank_mask:0xf
    v_and_b32_dpp v16, v35, v8 row_newbcast:4 row_mask:0xf bank_mask:0xf
    v_and_b32_dpp v17, v35, v9 row_newbcast:4 row_mask:0xf bank_mask:0xf
    s_nop 1
    v_mfma_f32_16x16x32_bf16 v[18:21], v[14:17], v[140:143], v[18:21]
    v_and_b32_dpp v10, v35, v6 row_newbcast:8 row_mask:0xf bank_mask:0xf
    v_and_b32_dpp v11, v35, v7 row_newbcast:8 row_mask:0xf bank_mask:0xf
    v_and_b32_dpp v12, v35, v8 row_newbcast:8 row_mask:0xf bank_mask:0xf
    v_and_b32_dpp v13, v35, v9 row_newbcast:8 row_mask:0xf bank_mask:0xf
    s_nop 1
    v_mfma_f32_16x16x32_bf16 v[18:21], v[10:13], v[40:43], v[18:21]
    v_and_b32_dpp v14, v35, v6 row_newbcast:12 row_mask:0xf bank_mask:0xf
    v_and_b32_dpp v15, v35, v7 row_newbcast:12 row_mask:0xf bank_mask:0xf
    v_and_b32_dpp v16, v35, v8 row_newbcast:12 row_mask:0xf bank_mask:0xf
    v_and_b32_dpp v17, v35, v9 row_newbcast:12 row_mask:0xf bank_mask:0xf
    s_nop 1
    v_mfma_f32_16x16x32_bf16 v[18:21], v[14:17], v[44:47], v[18:21]
    v_and_b32_dpp v10, v36, v6 row_newbcast:0 row_mask:0xf bank_mask:0xf
    v_and_b32_dpp v11, v36, v7 row_newbcast:0 row_mask:0xf bank_mask:0xf
    v_and_b32_dpp v12, v36, v8 row_newbcast:0 row_mask:0xf bank_mask:0xf
    v_and_b32_dpp v13, v36, v9 row_newbcast:0 row_mask:0xf bank_mask:0xf
    s_waitcnt vmcnt(3)
    s_xor_b32 s12, s14, 196608
    buffer_load_dwordx4 v[64:67], v1, s[48:51], s12 offen offset:0 nt
    v_mfma_f32_16x16x32_bf16 v[18:21], v[10:13], v[48:51], v[18:21]
    v_and_b32_dpp v14, v36, v6 row_newbcast:4 row_mask:0xf bank_mask:0xf
    v_and_b32_dpp v15, v36, v7 row_newbcast:4 row_mask:0xf bank_mask:0xf
    v_and_b32_dpp v16, v36, v8 row_newbcast:4 row_mask:0xf bank_mask:0xf
    v_and_b32_dpp v17, v36, v9 row_newbcast:4 row_mask:0xf bank_mask:0xf
    s_waitcnt vmcnt(3)
    buffer_load_dwordx4 v[68:71], v1, s[48:51], s12 offen offset:1024 nt
    v_mfma_f32_16x16x32_bf16 v[18:21], v[14:17], v[52:55], v[18:21]
    v_and_b32_dpp v10, v36, v6 row_newbcast:8 row_mask:0xf bank_mask:0xf
    v_and_b32_dpp v11, v36, v7 row_newbcast:8 row_mask:0xf bank_mask:0xf
    v_and_b32_dpp v12, v36, v8 row_newbcast:8 row_mask:0xf bank_mask:0xf
    v_and_b32_dpp v13, v36, v9 row_newbcast:8 row_mask:0xf bank_mask:0xf
    s_waitcnt vmcnt(3)
    buffer_load_dwordx4 v[72:75], v1, s[48:51], s12 offen offset:2048 nt
    v_mfma_f32_16x16x32_bf16 v[18:21], v[10:13], v[56:59], v[18:21]
    v_and_b32_dpp v14, v36, v6 row_newbcast:12 row_mask:0xf bank_mask:0xf
    v_and_b32_dpp v15, v36, v7 row_newbcast:12 row_mask:0xf bank_mask:0xf
    v_and_b32_dpp v16, v36, v8 row_newbcast:12 row_mask:0xf bank_mask:0xf
    v_and_b32_dpp v17, v36, v9 row_newbcast:12 row_mask:0xf bank_mask:0xf
    s_waitcnt vmcnt(3)
    buffer_load_dwordx4 v[76:79], v1, s[48:51], s12 offen offset:3072 nt
    v_mfma_f32_16x16x32_bf16 v[18:21], v[14:17], v[60:63], v[18:21]
    v_and_b32_dpp v10, v37, v6 row_newbcast:0 row_mask:0xf bank_mask:0xf
    v_and_b32_dpp v11, v37, v7 row_newbcast:0 row_mask:0xf bank_mask:0xf
    v_and_b32_dpp v12, v37, v8 row_newbcast:0 row_mask:0xf bank_mask:0xf
    v_and_b32_dpp v13, v37, v9 row_newbcast:0 row_mask:0xf bank_mask:0xf
    s_waitcnt vmcnt(3)
    s_xor_b32 s12, s15, 229376
    buffer_load_dwordx4 v[80:83], v1, s[48:51], s12 offen offset:0 nt
    v_mfma_f32_16x16x32_bf16 v[18:21], v[10:13], v[64:67], v[18:21]
    v_and_b32_dpp v14, v37, v6 row_newbcast:4 row_mask:0xf bank_mask:0xf
    v_and_b32_dpp v15, v37, v7 row_newbcast:4 row_mask:0xf bank_mask:0xf
    v_and_b32_dpp v16, v37, v8 row_newbcast:4 row_mask:0xf bank_mask:0xf
    v_and_b32_dpp v17, v37, v9 row_newbcast:4 row_mask:0xf bank_mask:0xf
    s_waitcnt vmcnt(3)
    buffer_load_dwordx4 v[84:87], v1, s[48:51], s12 offen offset:1024 nt
    v_mfma_f32_16x16x32_bf16 v[18:21], v[14:17], v[68:71], v[18:21]
    v_and_b32_dpp v10, v37, v6 row_newbcast:8 row_mask:0xf bank_mask:0xf
    v_and_b32_dpp v11, v37, v7 row_newbcast:8 row_mask:0xf bank_mask:0xf
    v_and_b32_dpp v12, v37, v8 row_newbcast:8 row_mask:0xf bank_mask:0xf
    v_and_b32_dpp v13, v37, v9 row_newbcast:8 row_mask:0xf bank_mask:0xf
    s_waitcnt vmcnt(3)
    buffer_load_dwordx4 v[88:91], v1, s[48:51], s12 offen offset:2048 nt
    v_mfma_f32_16x16x32_bf16 v[18:21], v[10:13], v[72:75], v[18:21]
    v_and_b32_dpp v14, v37, v6 row_newbcast:12 row_mask:0xf bank_mask:0xf
    v_and_b32_dpp v15, v37, v7 row_newbcast:12 row_mask:0xf bank_mask:0xf
    v_and_b32_dpp v16, v37, v8 row_newbcast:12 row_mask:0xf bank_mask:0xf
    v_and_b32_dpp v17, v37, v9 row_newbcast:12 row_mask:0xf bank_mask:0xf
    s_waitcnt vmcnt(3)
    buffer_load_dwordx4 v[92:95], v1, s[48:51], s12 offen offset:3072 nt
    v_mfma_f32_16x16x32_bf16 v[18:21], v[14:17], v[76:79], v[18:21]
    v_mov_b32 v2, 0
    s_mov_b64 s[72:73], exec
L_poll_4:
    ds_read_b32 v3, v2 offset:368
    s_waitcnt lgkmcnt(0)
    v_cmp_eq_u32 vcc, -1, v3
    s_nop 1
    s_cbranch_vccz L_pdone_5
    s_cmp_eq_u32 s8, 0
    s_cbranch_scc1 L_pdone_5
    s_sub_u32 s8, s8, 1
    s_mov_b64 exec, vcc
    s_sleep 1
    s_branch L_poll_4
L_pdone_5:
    s_mov_b64 exec, s[72:73]
    v_readfirstlane_b32 s26, v3
    s_and_b32 s27, s26, 3
    s_bfe_u32 s40, s26, 0x80008
    s_bfe_u32 s41, s26, 0x80010
    s_sub_u32 s11, s40, 27
    s_cmp_lt_u32 s40, 27
    s_cselect_b32 s56, s28, s30
    s_cselect_b32 s57, s29, s31
    s_cselect_b32 s11, s40, s11
    s_lshl_b32 s60, s11, 7
    s_mul_i32 s11, s41, 655360
    s_lshl_b32 s61, s40, 7
    s_add_u32 s11, s11, s61
    s_cmp_eq_u32 s27, 2
    s_cselect_b32 s58, 2211840, 0
    s_cmp_eq_u32 s27, 1
    s_cselect_b32 s56, s24, s56
    s_cselect_b32 s57, s25, s57
    s_cselect_b32 s58, 5242880, s58
    s_cselect_b32 s60, s11, s60
    s_cselect_b32 s77, 0x40000000, 0
    s_mov_b32 s61, 3456
    s_cselect_b32 s61, 1280, s61
    s_mov_b32 s11, 69120
    s_cselect_b32 s11, 20480, s11
    s_and_b32 s57, s57, 0xffff
    s_mov_b32 s59, 0x20000
    v_subrev_u32 v2, 256, v0
    v_lshrrev_b32 v2, 4, v2
    v_mul_lo_u32 v30, v2, s11
    v_and_b32 v2, 15, v0
    v_lshl_add_u32 v30, v2, 3, v30
    s_cmp_lg_u32 s27, 1
    s_cbranch_scc1 L_now_6
    v_and_b32 v24, 7, v0
    v_lshlrev_b32 v24, 3, v24
    s_mov_b64 s[72:73], exec
L_poll_7:
    ds_read_b32 v28, v24 offset:256
    s_waitcnt lgkmcnt(0)
    v_cmp_eq_u32 vcc, -1, v28
    s_nop 0
    s_cbranch_vccz L_pdone_8
    s_cmp_eq_u32 s8, 0
    s_cbranch_scc1 L_pdone_8
    s_sub_u32 s8, s8, 1
    s_mov_b64 exec, vcc
    s_sleep 2
    s_branch L_poll_7
L_pdone_8:
    s_mov_b64 exec, s[72:73]
    v_max_f32_dpp v28, v28, v28 quad_perm:[1,0,3,2] row_mask:0xf bank_mask:0xf
    s_nop 1
    v_max_f32_dpp v28, v28, v28 quad_perm:[2,3,0,1] row_mask:0xf bank_mask:0xf
    s_nop 1
    v_max_f32_dpp v28, v28, v28 row_half_mirror row_mask:0xf bank_mask:0xf
    v_sub_f32 v28, v26, v28
    v_mul_f32 v28, 0x3fb8aa3b, v28
    v_exp_f32 v28, v28
    s_mul_i32 s14, s6, 640
    s_add_u32 s14, s14, 81920
    v_and_b32 v24, 63, v0
    v_lshlrev_b32 v24, 3, v24
    v_mov_b32 v25, 0
    v_mov_b32 v29, 1
    buffer_load_dwordx2 v[96:97], v30, s[56:59], s60 offen nt
    s_add_u32 s60, s60, s61
    buffer_load_dwordx2 v[98:99], v30, s[56:59], s60 offen nt
    s_add_u32 s60, s60, s61
    buffer_load_dwordx2 v[100:101], v30, s[56:59], s60 offen nt
    s_add_u32 s60, s60, s61
    buffer_load_dwordx2 v[102:103], v30, s[56:59], s60 offen nt
    s_add_u32 s60, s60, s61
    buffer_load_dwordx2 v[104:105], v30, s[56:59], s60 offen nt
    s_add_u32 s60, s60, s61
    buffer_load_dwordx2 v[106:107], v30, s[56:59], s60 offen nt
    s_add_u32 s60, s60, s61
    buffer_load_dwordx2 v[108:109], v30, s[56:59], s60 offen nt
    s_add_u32 s60, s60, s61
    buffer_load_dwordx2 v[110:111], v30, s[56:59], s60 offen nt
    s_add_u32 s60, s60, s61
    v_and_b32_dpp v10, v38, v6 row_newbcast:0 row_mask:0xf bank_mask:0xf
    v_and_b32_dpp v11, v38, v7 row_newbcast:0 row_mask:0xf bank_mask:0xf
    v_and_b32_dpp v12, v38, v8 row_newbcast:0 row_mask:0xf bank_mask:0xf
    v_and_b32_dpp v13, v38, v9 row_newbcast:0 row_mask:0xf bank_mask:0xf
    s_waitcnt vmcnt(11)
    s_nop 0
    v_mfma_f32_16x16x32_bf16 v[18:21], v[10:13], v[80:83], v[18:21]
    buffer_load_dwordx2 v[112:113], v30, s[56:59], s60 offen nt
    s_add_u32 s60, s60, s61
    buffer_load_dwordx2 v[114:115], v30, s[56:59], s60 offen nt
    s_add_u32 s60, s60, s61
    buffer_load_dwordx2 v[116:117], v30, s[56:59], s60 offen nt
    s_add_u32 s60, s60, s61
    buffer_load_dwordx2 v[118:119], v30, s[56:59], s60 offen nt
    s_add_u32 s60, s60, s61
    buffer_load_dwordx2 v[120:121], v30, s[56:59], s60 offen nt
    s_add_u32 s60, s60, s61
    buffer_load_dwordx2 v[122:123], v30, s[56:59], s60 offen nt
    s_add_u32 s60, s60, s61
    buffer_load_dwordx2 v[124:125], v30, s[56:59], s60 offen nt
    s_add_u32 s60, s60, s61
    buffer_load_dwordx2 v[126:127], v30, s[56:59], s60 offen nt
    s_add_u32 s60, s60, s61
    s_add_u32 s60, s60, s77
    v_and_b32_dpp v14, v38, v6 row_newbcast:4 row_mask:0xf bank_mask:0xf
    v_and_b32_dpp v15, v38, v7 row_newbcast:4 row_mask:0xf bank_mask:0xf
    v_and_b32_dpp v16, v38, v8 row_newbcast:4 row_mask:0xf bank_mask:0xf
    v_and_b32_dpp v17, v38, v9 row_newbcast:4 row_mask:0xf bank_mask:0xf
    s_waitcnt vmcnt(18)
    s_nop 0
    v_mfma_f32_16x16x32_bf16 v[18:21], v[14:17], v[84:87], v[18:21]
    v_and_b32_dpp v10, v38, v6 row_newbcast:8 row_mask:0xf bank_mask:0xf
    v_and_b32_dpp v11, v38, v7 row_newbcast:8 row_mask:0xf bank_mask:0xf
    v_and_b32_dpp v12, v38, v8 row_newbcast:8 row_mask:0xf bank_mask:0xf
    v_and_b32_dpp v13, v38, v9 row_newbcast:8 row_mask:0xf bank_mask:0xf
    s_waitcnt vmcnt(17)
    s_nop 0
    v_mfma_f32_16x16x32_bf16 v[18:21], v[10:13], v[88:91], v[18:21]
    v_and_b32_dpp v14, v38, v6 row_newbcast:12 row_mask:0xf bank_mask:0xf
    v_and_b32_dpp v15, v38, v7 row_newbcast:12 row_mask:0xf bank_mask:0xf
    v_and_b32_dpp v16, v38, v8 row_newbcast:12 row_mask:0xf bank_mask:0xf
    v_and_b32_dpp v17, v38, v9 row_newbcast:12 row_mask:0xf bank_mask:0xf
    s_waitcnt vmcnt(16)
    s_nop 0
    v_mfma_f32_16x16x32_bf16 v[18:21], v[14:17], v[92:95], v[18:21]
    s_mov_b32 s58, 0
    s_nop 5
    s_branch L_bulk_fin
L_now_6:
    v_and_b32 v24, 7, v0
    v_lshlrev_b32 v24, 3, v24
    s_mov_b64 s[72:73], exec
L_poll_9:
    ds_read_b32 v28, v24 offset:256
    s_waitcnt lgkmcnt(0)
    v_cmp_eq_u32 vcc, -1, v28
    s_nop 0
    s_cbranch_vccz L_pdone_10
    s_cmp_eq_u32 s8, 0
    s_cbranch_scc1 L_pdone_10
    s_sub_u32 s8, s8, 1
    s_mov_b64 exec, vcc
    s_sleep 2
    s_branch L_poll_9
L_pdone_10:
    s_mov_b64 exec, s[72:73]
    v_max_f32_dpp v28, v28, v28 quad_perm:[1,0,3,2] row_mask:0xf bank_mask:0xf
    s_nop 1
    v_max_f32_dpp v28, v28, v28 quad_perm:[2,3,0,1] row_mask:0xf bank_mask:0xf
    s_nop 1
    v_max_f32_dpp v28, v28, v28 row_half_mirror row_mask:0xf bank_mask:0xf
    v_sub_f32 v28, v26, v28
    v_mul_f32 v28, 0x3fb8aa3b, v28
    v_exp_f32 v28, v28
    s_mul_i32 s14, s6, 640
    s_add_u32 s14, s14, 81920
    v_and_b32 v24, 63, v0
    v_lshlrev_b32 v24, 3, v24
    v_mov_b32 v25, 0
    v_mov_b32 v29, 1
    v_and_b32_dpp v10, v38, v6 row_newbcast:0 row_mask:0xf bank_mask:0xf
    v_and_b32_dpp v11, v38, v7 row_newbcast:0 row_mask:0xf bank_mask:0xf
    v_and_b32_dpp v12, v38, v8 row_newbcast:0 row_mask:0xf bank_mask:0xf
    v_and_b32_dpp v13, v38, v9 row_newbcast:0 row_mask:0xf bank_mask:0xf
    s_waitcnt vmcnt(3)
    s_nop 0
    v_mfma_f32_16x16x32_bf16 v[18:21], v[10:13], v[80:83], v[18:21]
    v_and_b32_dpp v14, v38, v6 row_newbcast:4 row_mask:0xf bank_mask:0xf
    v_and_b32_dpp v15, v38, v7 row_newbcast:4 row_mask:0xf bank_mask:0xf
    v_and_b32_dpp v16, v38, v8 row_newbcast:4 row_mask:0xf bank_mask:0xf
    v_and_b32_dpp v17, v38, v9 row_newbcast:4 row_mask:0xf bank_mask:0xf
    s_waitcnt vmcnt(2)
    s_nop 0
    v_mfma_f32_16x16x32_bf16 v[18:21], v[14:17], v[84:87], v[18:21]
    v_and_b32_dpp v10, v38, v6 row_newbcast:8 row_mask:0xf bank_mask:0xf
    v_and_b32_dpp v11, v38, v7 row_newbcast:8 row_mask:0xf bank_mask:0xf
    v_and_b32_dpp v12, v38, v8 row_newbcast:8 row_mask:0xf bank_mask:0xf
    v_and_b32_dpp v13, v38, v9 row_newbcast:8 row_mask:0xf bank_mask:0xf
    s_waitcnt vmcnt(1)
    s_nop 0
    v_mfma_f32_16x16x32_bf16 v[18:21], v[10:13], v[88:91], v[18:21]
    v_and_b32_dpp v14, v38, v6 row_newbcast:12 row_mask:0xf bank_mask:0xf
    v_and_b32_dpp v15, v38, v7 row_newbcast:12 row_mask:0xf bank_mask:0xf
    v_and_b32_dpp v16, v38, v8 row_newbcast:12 row_mask:0xf bank_mask:0xf
    v_and_b32_dpp v17, v38, v9 row_newbcast:12 row_mask:0xf bank_mask:0xf
    s_waitcnt vmcnt(0)
    s_nop 0
    v_mfma_f32_16x16x32_bf16 v[18:21], v[14:17], v[92:95], v[18:21]
L_bulk_fin:
    s_mov_b32 exec_hi, 0
    s_nop 6
    v_mul_f32 v18, v28, v18
    v_mul_f32 v19, v28, v19
    v_mul_f32 v20, v28, v20
    v_mul_f32 v21, v28, v21
    ds_write_b128 v22, v[18:21] offset:512
    s_mov_b64 exec, 1
    ds_add_rtn_u32 v23, v25, v29 offset:356
    s_mov_b64 exec, -1
    s_waitcnt lgkmcnt(0)
    v_readfirstlane_b32 s11, v23
    s_cmp_lg_u32 s11, 6
    s_nop 2
    s_cbranch_scc1 L_notlast_11
    ds_read_b64 v[40:41], v24 offset:512
    ds_read_b64 v[42:43], v24 offset:1024
    ds_read_b64 v[44:45], v24 offset:1536
    ds_read_b64 v[46:47], v24 offset:2048
    ds_read_b64 v[48:49], v24 offset:2560
    ds_read_b64 v[50:51], v24 offset:3072
    ds_read_b64 v[52:53], v24 offset:3584
    ds_read_b64 v[54:55], v24 offset:4096
    s_waitcnt lgkmcnt(6)
    v_pk_add_f32 v[40:41], v[40:41], v[42:43]
    s_waitcnt lgkmcnt(4)
    v_pk_add_f32 v[44:45], v[44:45], v[46:47]
    v_pk_add_f32 v[40:41], v[40:41], v[44:45]
    s_waitcnt lgkmcnt(2)
    v_pk_add_f32 v[48:49], v[48:49], v[50:51]
    v_pk_add_f32 v[40:41], v[40:41], v[48:49]
    s_waitcnt lgkmcnt(0)
    v_pk_add_f32 v[52:53], v[52:53], v[54:55]
    v_pk_add_f32 v[40:41], v[40:41], v[52:53]
    v_min_u32 v40, 0xfffffffe, v40
    v_min_u32 v41, 0xfffffffe, v41
    buffer_store_dwordx2 v[40:41], v24, s[52:55], s14 offen sc1
    ds_write_b32 v25, v25 offset:360
L_notlast_11:
    s_cmp_eq_u32 s58, 0
    s_cbranch_scc1 L_tail
    buffer_load_dwordx2 v[96:97], v30, s[56:59], s60 offen nt
    s_add_u32 s60, s60, s61
    buffer_load_dwordx2 v[98:99], v30, s[56:59], s60 offen nt
    s_add_u32 s60, s60, s61
    buffer_load_dwordx2 v[100:101], v30, s[56:59], s60 offen nt
    s_add_u32 s60, s60, s61
    buffer_load_dwordx2 v[102:103], v30, s[56:59], s60 offen nt
    s_add_u32 s60, s60, s61
    buffer_load_dwordx2 v[104:105], v30, s[56:59], s60 offen nt
    s_add_u32 s60, s60, s61
    buffer_load_dwordx2 v[106:107], v30, s[56:59], s60 offen nt
    s_add_u32 s60, s60, s61
    buffer_load_dwordx2 v[108:109], v30, s[56:59], s60 offen nt
    s_add_u32 s60, s60, s61
    buffer_load_dwordx2 v[110:111], v30, s[56:59], s60 offen nt
    s_add_u32 s60, s60, s61
    buffer_load_dwordx2 v[112:113], v30, s[56:59], s60 offen nt
    s_add_u32 s60, s60, s61
    buffer_load_dwordx2 v[114:115], v30, s[56:59], s60 offen nt
    s_add_u32 s60, s60, s61
    buffer_load_dwordx2 v[116:117], v30, s[56:59], s60 offen nt
    s_add_u32 s60, s60, s61
    buffer_load_dwordx2 v[118:119], v30, s[56:59], s60 offen nt
    s_add_u32 s60, s60, s61
    buffer_load_dwordx2 v[120:121], v30, s[56:59], s60 offen nt
    s_add_u32 s60, s60, s61
    buffer_load_dwordx2 v[122:123], v30, s[56:59], s60 offen nt
    s_add_u32 s60, s60, s61
    buffer_load_dwordx2 v[124:125], v30, s[56:59], s60 offen nt
    s_add_u32 s60, s60, s61
    buffer_load_dwordx2 v[126:127], v30, s[56:59], s60 offen nt
    s_add_u32 s60, s60, s61
    s_add_u32 s60, s60, s77
    buffer_load_dwordx2 v[128:129], v30, s[56:59], s60 offen nt
    s_add_u32 s60, s60, s61
    buffer_load_dwordx2 v[130:131], v30, s[56:59], s60 offen nt
    s_add_u32 s60, s60, s61
    buffer_load_dwordx2 v[132:133], v30, s[56:59], s60 offen nt
    s_add_u32 s60, s60, s61
    buffer_load_dwordx2 v[134:135], v30, s[56:59], s60 offen nt
    s_add_u32 s60, s60, s61
L_tail:
    s_cmp_eq_u32 s27, 0
    s_cbranch_scc1 L_fin
    v_subrev_u32 v1, 256, v0
    v_and_b32 v2, 63, v0
    v_and_b32 v3, 15, v0
    v_mov_b32 v20, 0
    v_mov_b32 v21, 0
    v_mov_b32 v22, 0
    v_mov_b32 v23, 0
    v_mov_b32 v24, 0
    v_mov_b32 v25, 0
    v_mov_b32 v26, 0
    v_mov_b32 v27, 0
    v_mov_b32 v80, v30
    s_mov_b64 s[72:73], exec
    s_cbranch_execz L_pdone_13
L_poll_12:
    ds_read_b32 v7, v20 offset:364
    s_waitcnt lgkmcnt(0)
    v_cmp_eq_u32 vcc, -1, v7
    s_nop 0
    s_cbranch_vccz L_pdone_13
    s_cmp_eq_u32 s8, 0
    s_cbranch_scc1 L_pdone_13
    s_sub_u32 s8, s8, 1
    s_mov_b64 exec, vcc
    s_sleep 2
    s_branch L_poll_12
L_pdone_13:
    s_mov_b64 exec, s[72:73]
    v_readfirstlane_b32 s9, v7
    s_and_b32 s9, s9, 8192
    s_mov_b64 s[72:73], exec
    s_nop 1
    s_cbranch_execz L_pdone_15
L_poll_14:
    ds_read_b32 v7, v20 offset:360
    s_waitcnt lgkmcnt(0)
    v_cmp_eq_u32 vcc, -1, v7
    s_nop 0
    s_cbranch_vccz L_pdone_15
    s_cmp_eq_u32 s8, 0
    s_cbranch_scc1 L_pdone_15
    s_sub_u32 s8, s8, 1
    s_mov_b64 exec, vcc
    s_sleep 2
    s_branch L_poll_14
L_pdone_15:
    s_mov_b64 exec, s[72:73]
L_nodone:
    s_cmp_eq_u32 s27, 3
    s_cbranch_scc1 L_dn
    v_lshrrev_b32 v16, 4, v2
    v_lshl_add_u32 v16, v3, 2, v16
    s_lshl_b32 s11, s10, 8
    s_add_u32 s11, s11, 4736
    v_lshl_add_u32 v16, v16, 2, s11
    v_lshlrev_b32 v17, 2, v2
    v_add_u32 v18, 4736, v17
    s_cmp_eq_u32 s27, 2
    s_cbranch_scc1 L_gu
    s_lshr_b32 s12, s10, 1
    s_mul_i32 s13, s41, 4
    s_add_u32 s12, s12, s13
    s_mul_i32 s12, s12, 5120
    s_add_u32 s12, s12, 81920
    s_mul_i32 s13, s41, 11
    s_lshr_b32 s13, s13, 5
    s_mul_i32 s13, s13, 8704
    s_mul_i32 s15, s41, 2560
    s_add_u32 s15, s15, s13
    s_add_u32 s15, s15, 16384
    s_lshl_b32 s13, s40, 8
    s_add_u32 s15, s15, s13
    s_add_u32 s15, s15, s9
    v_lshrrev_b32 v5, 3, v3
    v_mul_u32_u24 v5, 2560, v5
    v_bfe_u32 v4, v1, 4, 3
    v_lshlrev_b32 v4, 6, v4
    v_and_b32 v6, 7, v3
    v_lshl_add_u32 v4, v6, 3, v4
    v_add_u32 v4, v4, v5
    s_mov_b64 s[72:73], exec
    s_cbranch_execz L_ps_19
    buffer_load_dwordx2 v[44:45], v5, s[52:55], s12 offen offset:512 sc1
    buffer_load_dwordx2 v[46:47], v5, s[52:55], s12 offen offset:1152 sc1
    buffer_load_dwordx2 v[48:49], v5, s[52:55], s12 offen offset:1792 sc1
    buffer_load_dwordx2 v[50:51], v5, s[52:55], s12 offen offset:2432 sc1
    buffer_load_dwordx2 v[28:29], v4, s[52:55], s12 offen offset:0 sc1
    buffer_load_dwordx2 v[30:31], v4, s[52:55], s12 offen offset:640 sc1
    buffer_load_dwordx2 v[32:33], v4, s[52:55], s12 offen offset:1280 sc1
    buffer_load_dwordx2 v[34:35], v4, s[52:55], s12 offen offset:1920 sc1
    s_waitcnt vmcnt(8)
    s_branch L_ps_192
L_ps_19:
    s_waitcnt vmcnt(0)
L_ps_192:
    v_perm_b32 v92, v98, v96, s74
    v_perm_b32 v98, v98, v96, s75
    v_perm_b32 v96, v99, v97, s74
    v_perm_b32 v99, v99, v97, s75
    v_perm_b32 v97, v102, v100, s74
    v_perm_b32 v102, v102, v100, s75
    v_perm_b32 v100, v103, v101, s74
    v_perm_b32 v103, v103, v101, s75
    v_perm_b32 v101, v106, v104, s74
    v_perm_b32 v106, v106, v104, s75
    v_perm_b32 v104, v107, v105, s74
    v_perm_b32 v107, v107, v105, s75
    v_perm_b32 v105, v110, v108, s74
    v_perm_b32 v110, v110, v108, s75
    v_perm_b32 v108, v111, v109, s74
    v_perm_b32 v111, v111, v109, s75
    v_perm_b32 v109, v114, v112, s74
    v_perm_b32 v114, v114, v112, s75
    v_perm_b32 v112, v115, v113, s74
    v_perm_b32 v115, v115, v113, s75
    v_perm_b32 v113, v118, v116, s74
    v_perm_b32 v118, v118, v116, s75
    v_perm_b32 v116, v119, v117, s74
    v_perm_b32 v119, v119, v117, s75
    v_perm_b32 v117, v122, v120, s74
    v_perm_b32 v122, v122, v120, s75
    v_perm_b32 v120, v123, v121, s74
    v_perm_b32 v123, v123, v121, s75
    v_perm_b32 v121, v126, v124, s74
    v_perm_b32 v126, v126, v124, s75
    v_perm_b32 v124, v127, v125, s74
    v_perm_b32 v127, v127, v125, s75
    s_mov_b64 exec, s[72:73]
    s_cbranch_execz L_pdone_18
    s_branch L_pw_17
L_poll_16:
    buffer_load_dwordx2 v[44:45], v5, s[52:55], s12 offen offset:512 sc1
    buffer_load_dwordx2 v[46:47], v5, s[52:55], s12 offen offset:1152 sc1
    buffer_load_dwordx2 v[48:49], v5, s[52:55], s12 offen offset:1792 sc1
    buffer_load_dwordx2 v[50:51], v5, s[52:55], s12 offen offset:2432 sc1
    buffer_load_dwordx2 v[28:29], v4, s[52:55], s12 offen offset:0 sc1
    buffer_load_dwordx2 v[30:31], v4, s[52:55], s12 offen offset:640 sc1
    buffer_load_dwordx2 v[32:33], v4, s[52:55], s12 offen offset:1280 sc1
    buffer_load_dwordx2 v[34:35], v4, s[52:55], s12 offen offset:1920 sc1
L_pw_17:
    s_waitcnt vmcnt(0)
    v_max3_u32 v6, v44, v45, v46
    v_max3_u32 v6, v6, v47, v48
    v_max3_u32 v6, v6, v49, v50
    v_max_u32 v6, v6, v51
    v_cmp_eq_u32 vcc, -1, v6
    s_nop 0
    s_cbranch_vccz L_pdone_18
    s_cmp_eq_u32 s8, 0
    s_cbranch_scc1 L_pdone_18
    s_sub_u32 s8, s8, 1
    s_mov_b64 exec, vcc
    s_sleep 2
    s_branch L_poll_16
L_pdone_18:
    s_mov_b64 exec, s[62:63]
    v_max_f32 v6, v44, v46
    v_max3_f32 v6, v6, v48, v50
    s_nop 1
    v_max_f32_dpp v6, v6, v6 row_ror:8 row_mask:0xf bank_mask:0xf
    v_sub_f32 v8, v44, v6
    v_sub_f32 v9, v46, v6
    v_sub_f32 v10, v48, v6
    v_sub_f32 v11, v50, v6
    v_mul_f32 v8, 0x3fb8aa3b, v8
    v_mul_f32 v9, 0x3fb8aa3b, v9
    v_mul_f32 v10, 0x3fb8aa3b, v10
    v_mul_f32 v11, 0x3fb8aa3b, v11
    v_exp_f32 v8, v8
    v_exp_f32 v9, v9
    v_exp_f32 v10, v10
    v_exp_f32 v11, v11
    v_mul_f32 v6, v8, v45
    v_fmac_f32 v6, v9, v47
    v_fmac_f32 v6, v10, v49
    v_fmac_f32 v6, v11, v51
    s_nop 1
    v_add_f32_dpp v6, v6, v6 row_ror:8 row_mask:0xf bank_mask:0xf
    v_rcp_f32 v6, v6
    s_nop 0
    v_mul_f32 v8, v8, v6
    v_mul_f32 v9, v9, v6
    v_mul_f32 v10, v10, v6
    v_mul_f32 v11, v11, v6
    v_max3_u32 v6, v28, v29, v30
    v_max3_u32 v6, v6, v31, v32
    v_max3_u32 v6, v6, v33, v34
    v_max_u32 v6, v6, v35
    v_cmp_eq_u32 vcc, -1, v6
    s_nop 0
    s_cbranch_vccz L_oa_ok
    s_mov_b64 s[72:73], exec
    s_cbranch_execz L_pdone_21
L_poll_20:
    buffer_load_dwordx2 v[28:29], v4, s[52:55], s12 offen offset:0 sc1
    buffer_load_dwordx2 v[30:31], v4, s[52:55], s12 offen offset:640 sc1
    buffer_load_dwordx2 v[32:33], v4, s[52:55], s12 offen offset:1280 sc1
    buffer_load_dwordx2 v[34:35], v4, s[52:55], s12 offen offset:1920 sc1
    s_waitcnt vmcnt(0)
    v_max3_u32 v6, v28, v29, v30
    v_max3_u32 v6, v6, v31, v32
    v_max3_u32 v6, v6, v33, v34
    v_max_u32 v6, v6, v35
    v_cmp_eq_u32 vcc, -1, v6
    s_nop 0
    s_cbranch_vccz L_pdone_21
    s_cmp_eq_u32 s8, 0
    s_cbranch_scc1 L_pdone_21
    s_sub_u32 s8, s8, 1
    s_mov_b64 exec, vcc
    s_branch L_poll_20
L_pdone_21:
    s_mov_b64 exec, s[72:73]
L_oa_ok:
    v_mul_f32 v6, v8, v28
    v_mul_f32 v7, v8, v29
    v_fmac_f32 v6, v9, v30
    v_fmac_f32 v7, v9, v31
    v_fmac_f32 v6, v10, v32
    v_fmac_f32 v7, v10, v33
    v_fmac_f32 v6, v11, v34
    v_fmac_f32 v7, v11, v35
    s_nop 0
    v_add_f32_dpp v6, v6, v6 row_ror:8 row_mask:0xf bank_mask:0xf
    v_add_f32_dpp v7, v7, v7 row_ror:8 row_mask:0xf bank_mask:0xf
    v_cvt_pk_bf16_f32 v6, v6, v7
    s_nop 1
    v_dot2c_f32_bf16_dpp v20, v6, v92 row_newbcast:0 row_mask:0xf bank_mask:0xf
    v_dot2c_f32_bf16_dpp v21, v6, v98 row_newbcast:0 row_mask:0xf bank_mask:0xf
    v_dot2c_f32_bf16_dpp v22, v6, v96 row_newbcast:0 row_mask:0xf bank_mask:0xf
    v_dot2c_f32_bf16_dpp v23, v6, v99 row_newbcast:0 row_mask:0xf bank_mask:0xf
    v_dot2c_f32_bf16_dpp v20, v6, v97 row_newbcast:1 row_mask:0xf bank_mask:0xf
    v_dot2c_f32_bf16_dpp v21, v6, v102 row_newbcast:1 row_mask:0xf bank_mask:0xf
    v_dot2c_f32_bf16_dpp v22, v6, v100 row_newbcast:1 row_mask:0xf bank_mask:0xf
    v_dot2c_f32_bf16_dpp v23, v6, v103 row_newbcast:1 row_mask:0xf bank_mask:0xf
    v_dot2c_f32_bf16_dpp v20, v6, v101 row_newbcast:2 row_mask:0xf bank_mask:0xf
    v_dot2c_f32_bf16_dpp v21, v6, v106 row_newbcast:2 row_mask:0xf bank_mask:0xf
    v_dot2c_f32_bf16_dpp v22, v6, v104 row_newbcast:2 row_mask:0xf bank_mask:0xf
    v_dot2c_f32_bf16_dpp v23, v6, v107 row_newbcast:2 row_mask:0xf bank_mask:0xf
    v_dot2c_f32_bf16_dpp v20, v6, v105 row_newbcast:3 row_mask:0xf bank_mask:0xf
    v_dot2c_f32_bf16_dpp v21, v6, v110 row_newbcast:3 row_mask:0xf bank_mask:0xf
    v_dot2c_f32_bf16_dpp v22, v6, v108 row_newbcast:3 row_mask:0xf bank_mask:0xf
    v_dot2c_f32_bf16_dpp v23, v6, v111 row_newbcast:3 row_mask:0xf bank_mask:0xf
    v_dot2c_f32_bf16_dpp v20, v6, v109 row_newbcast:4 row_mask:0xf bank_mask:0xf
    v_dot2c_f32_bf16_dpp v21, v6, v114 row_newbcast:4 row_mask:0xf bank_mask:0xf
    v_dot2c_f32_bf16_dpp v22, v6, v112 row_newbcast:4 row_mask:0xf bank_mask:0xf
    v_dot2c_f32_bf16_dpp v23, v6, v115 row_newbcast:4 row_mask:0xf bank_mask:0xf
    v_dot2c_f32_bf16_dpp v20, v6, v113 row_newbcast:5 row_mask:0xf bank_mask:0xf
    v_dot2c_f32_bf16_dpp v21, v6, v118 row_newbcast:5 row_mask:0xf bank_mask:0xf
    v_dot2c_f32_bf16_dpp v22, v6, v116 row_newbcast:5 row_mask:0xf bank_mask:0xf
    v_dot2c_f32_bf16_dpp v23, v6, v119 row_newbcast:5 row_mask:0xf bank_mask:0xf
    v_dot2c_f32_bf16_dpp v20, v6, v117 row_newbcast:6 row_mask:0xf bank_mask:0xf
    v_dot2c_f32_bf16_dpp v21, v6, v122 row_newbcast:6 row_mask:0xf bank_mask:0xf
    v_dot2c_f32_bf16_dpp v22, v6, v120 row_newbcast:6 row_mask:0xf bank_mask:0xf
    v_dot2c_f32_bf16_dpp v23, v6, v123 row_newbcast:6 row_mask:0xf bank_mask:0xf
    v_dot2c_f32_bf16_dpp v20, v6, v121 row_newbcast:7 row_mask:0xf bank_mask:0xf
    v_dot2c_f32_bf16_dpp v21, v6, v126 row_newbcast:7 row_mask:0xf bank_mask:0xf
    v_dot2c_f32_bf16_dpp v22, v6, v124 row_newbcast:7 row_mask:0xf bank_mask:0xf
    v_dot2c_f32_bf16_dpp v23, v6, v127 row_newbcast:7 row_mask:0xf bank_mask:0xf
    s_nop 1
    v_permlane32_swap_b32 v20, v22
    v_permlane32_swap_b32 v21, v23
    v_add_f32 v20, v20, v22
    v_add_f32 v21, v21, v23
    s_nop 1
    v_permlane16_swap_b32 v20, v21
    v_add_f32 v20, v20, v21
    ds_write_b32 v16, v20
    s_waitcnt lgkmcnt(0)
    s_cbranch_execz L_nb_22
    s_barrier
L_nb_22:
    s_cmp_lg_u32 s10, 0
    s_cbranch_scc1 L_fin
    ds_read2st64_b32 v[28:29], v18 offset0:0 offset1:1
    ds_read2st64_b32 v[30:31], v18 offset0:2 offset1:3
    ds_read2st64_b32 v[32:33], v18 offset0:4 offset1:5
    ds_read2st64_b32 v[34:35], v18 offset0:6 offset1:7
    s_waitcnt lgkmcnt(3)
    v_add_f32 v28, v28, v29
    s_waitcnt lgkmcnt(2)
    v_add_f32 v30, v30, v31
    v_add_f32 v28, v28, v30
    s_waitcnt lgkmcnt(1)
    v_add_f32 v32, v32, v33
    s_waitcnt lgkmcnt(0)
    v_add_f32 v34, v34, v35
    v_add_f32 v32, v32, v34
    v_add_f32 v28, v28, v32
    v_min_u32 v28, 0xfffffffe, v28
    s_nop 0
    s_cbranch_execz L_nm_23
    buffer_store_dword v28, v17, s[52:55], s15 offen sc1
L_nm_23:
    s_branch L_fin
L_gu:
    v_lshrrev_b32 v4, 4, v1
    v_mul_u32_u24 v4, 10, v4
    v_add_u32 v4, v4, v3
    v_lshlrev_b32 v5, 2, v4
    v_lshlrev_b32 v4, 3, v4
    v_mov_b32 v14, 0
    v_mov_b32 v15, 0
    v_and_b32 v72, 32, v2
    s_lshl_b32 s11, s10, 2
    v_add_u32 v72, s11, v72
    v_lshlrev_b32 v73, 2, v3
    s_lshl_b32 s15, s40, 7
    s_add_u32 s15, s15, 65536
    s_mov_b32 s12, 245760
    v_mov_b32 v74, 0x3acccccd
    s_and_b32 exec_lo, s62, 0x3ff03ff
    s_and_b32 exec_hi, s62, 0x3ff03ff
    ds_read_b32 v28, v5 offset:10880
    ds_read_b32 v29, v5 offset:12160
    ds_read_b32 v30, v5 offset:13440
    ds_read_b32 v31, v5 offset:14720
    s_waitcnt lgkmcnt(0)
    v_lshlrev_b32 v6, 16, v28
    v_and_b32 v7, s76, v28
    v_lshlrev_b32 v8, 16, v29
    v_and_b32 v9, s76, v29
    v_lshlrev_b32 v10, 16, v30
    v_and_b32 v11, s76, v30
    v_lshlrev_b32 v12, 16, v31
    v_and_b32 v13, s76, v31
    v_add_f32 v10, 1.0, v10
    v_add_f32 v11, 1.0, v11
    v_cvt_pk_bf16_f32 v68, v10, v11
    v_lshlrev_b32 v10, 16, v68
    v_and_b32 v11, s76, v68
    v_mov_b32 v82, v68
    v_mov_b32 v83, v29
    v_add_f32 v14, v12, v13
    s_mov_b64 exec, s[62:63]
    s_nop 0
    v_add_f32_dpp v14, v14, v14 quad_perm:[1,0,3,2] row_mask:0xf bank_mask:0xf
    s_nop 1
    v_add_f32_dpp v14, v14, v14 quad_perm:[2,3,0,1] row_mask:0xf bank_mask:0xf
    s_nop 1
    v_add_f32_dpp v14, v14, v14 row_ror:4 row_mask:0xf bank_mask:0xf
    s_nop 1
    v_add_f32_dpp v14, v14, v14 row_ror:8 row_mask:0xf bank_mask:0xf
    v_mov_b32 v15, v14
    s_nop 1
    v_permlane16_swap_b32 v15, v14
    v_add_f32 v14, v14, v15
    v_mov_b32 v15, v14
    s_nop 1
    v_permlane32_swap_b32 v15, v14
    v_add_f32 v14, v14, v15
    v_mul_f32 v81, 0x3c4ccccd, v14
    v_mul_f32 v84, v81, v10
    v_mul_f32 v85, v81, v11
    v_mov_b32 v14, 0
    v_mov_b32 v15, 0
    s_mov_b64 exec, s[62:63]
    s_mul_i32 s13, s10, 11
    s_lshr_b32 s13, s13, 5
    s_mul_i32 s13, s13, 8704
    s_mul_i32 s14, s10, 2560
    s_add_u32 s14, s14, s13
    s_add_u32 s14, s14, 16384
    s_add_u32 s14, s14, s9
    s_add_u32 s15, s15, s9
    v_lshlrev_b32 v75, 4, v2
    s_mul_i32 s13, s10, 2560
    s_add_u32 s13, s13, 16000
    v_add_u32 v76, s13, v75
    v_add_u32 v4, 16000, v4
    v_mov_b32 v77, 0x7fffffff
    v_cmp_gt_u32 vcc, 32, v2
    s_nop 1
    v_cndmask_b32 v77, v77, v75, vcc
    s_mov_b64 s[72:73], exec
    s_cbranch_execz L_ps_27
    buffer_load_dwordx4 v[28:31], v75, s[52:55], s14 offen sc1
    buffer_load_dwordx4 v[32:35], v75, s[52:55], s14 offen offset:1024 sc1
    buffer_load_dwordx4 v[36:39], v77, s[52:55], s14 offen offset:2048 sc1
    s_branch L_ps_272
L_ps_27:
    s_waitcnt vmcnt(0)
L_ps_272:
    v_mov_b32 v44, 0
    v_mov_b32 v45, 0
    v_mov_b32 v46, 0
    v_mov_b32 v47, 0
    s_waitcnt vmcnt(21)
    v_perm_b32 v92, v98, v96, s74
    v_perm_b32 v98, v98, v96, s75
    v_perm_b32 v96, v99, v97, s74
    v_perm_b32 v99, v99, v97, s75
    v_dot2c_f32_bf16_dpp v44, v82, v92 row_newbcast:0 row_mask:0xf bank_mask:0xf
    v_dot2c_f32_bf16_dpp v45, v82, v98 row_newbcast:0 row_mask:0xf bank_mask:0xf
    v_dot2c_f32_bf16_dpp v46, v82, v96 row_newbcast:0 row_mask:0xf bank_mask:0xf
    v_dot2c_f32_bf16_dpp v47, v82, v99 row_newbcast:0 row_mask:0xf bank_mask:0xf
    v_dot2c_f32_bf16_dpp v24, v83, v92 row_newbcast:0 row_mask:0xf bank_mask:0xf
    v_dot2c_f32_bf16_dpp v25, v83, v98 row_newbcast:0 row_mask:0xf bank_mask:0xf
    v_dot2c_f32_bf16_dpp v26, v83, v96 row_newbcast:0 row_mask:0xf bank_mask:0xf
    v_dot2c_f32_bf16_dpp v27, v83, v99 row_newbcast:0 row_mask:0xf bank_mask:0xf
    s_waitcnt vmcnt(19)
    v_perm_b32 v97, v102, v100, s74
    v_perm_b32 v102, v102, v100, s75
    v_perm_b32 v100, v103, v101, s74
    v_perm_b32 v103, v103, v101, s75
    v_dot2c_f32_bf16_dpp v44, v82, v97 row_newbcast:1 row_mask:0xf bank_mask:0xf
    v_dot2c_f32_bf16_dpp v45, v82, v102 row_newbcast:1 row_mask:0xf bank_mask:0xf
    v_dot2c_f32_bf16_dpp v46, v82, v100 row_newbcast:1 row_mask:0xf bank_mask:0xf
    v_dot2c_f32_bf16_dpp v47, v82, v103 row_newbcast:1 row_mask:0xf bank_mask:0xf
    v_dot2c_f32_bf16_dpp v24, v83, v97 row_newbcast:1 row_mask:0xf bank_mask:0xf
    v_dot2c_f32_bf16_dpp v25, v83, v102 row_newbcast:1 row_mask:0xf bank_mask:0xf
    v_dot2c_f32_bf16_dpp v26, v83, v100 row_newbcast:1 row_mask:0xf bank_mask:0xf
    v_dot2c_f32_bf16_dpp v27, v83, v103 row_newbcast:1 row_mask:0xf bank_mask:0xf
    s_waitcnt vmcnt(17)
    v_perm_b32 v101, v106, v104, s74
    v_perm_b32 v106, v106, v104, s75
    v_perm_b32 v104, v107, v105, s74
    v_perm_b32 v107, v107, v105, s75
    v_dot2c_f32_bf16_dpp v44, v82, v101 row_newbcast:2 row_mask:0xf bank_mask:0xf
    v_dot2c_f32_bf16_dpp v45, v82, v106 row_newbcast:2 row_mask:0xf bank_mask:0xf
    v_dot2c_f32_bf16_dpp v46, v82, v104 row_newbcast:2 row_mask:0xf bank_mask:0xf
    v_dot2c_f32_bf16_dpp v47, v82, v107 row_newbcast:2 row_mask:0xf bank_mask:0xf
    v_dot2c_f32_bf16_dpp v24, v83, v101 row_newbcast:2 row_mask:0xf bank_mask:0xf
    v_dot2c_f32_bf16_dpp v25, v83, v106 row_newbcast:2 row_mask:0xf bank_mask:0xf
    v_dot2c_f32_bf16_dpp v26, v83, v104 row_newbcast:2 row_mask:0xf bank_mask:0xf
    v_dot2c_f32_bf16_dpp v27, v83, v107 row_newbcast:2 row_mask:0xf bank_mask:0xf
    s_waitcnt vmcnt(15)
    v_perm_b32 v105, v110, v108, s74
    v_perm_b32 v110, v110, v108, s75
    v_perm_b32 v108, v111, v109, s74
    v_perm_b32 v111, v111, v109, s75
    v_dot2c_f32_bf16_dpp v44, v82, v105 row_newbcast:3 row_mask:0xf bank_mask:0xf
    v_dot2c_f32_bf16_dpp v45, v82, v110 row_newbcast:3 row_mask:0xf bank_mask:0xf
    v_dot2c_f32_bf16_dpp v46, v82, v108 row_newbcast:3 row_mask:0xf bank_mask:0xf
    v_dot2c_f32_bf16_dpp v47, v82, v111 row_newbcast:3 row_mask:0xf bank_mask:0xf
    v_dot2c_f32_bf16_dpp v24, v83, v105 row_newbcast:3 row_mask:0xf bank_mask:0xf
    v_dot2c_f32_bf16_dpp v25, v83, v110 row_newbcast:3 row_mask:0xf bank_mask:0xf
    v_dot2c_f32_bf16_dpp v26, v83, v108 row_newbcast:3 row_mask:0xf bank_mask:0xf
    v_dot2c_f32_bf16_dpp v27, v83, v111 row_newbcast:3 row_mask:0xf bank_mask:0xf
    s_waitcnt vmcnt(13)
    v_perm_b32 v109, v114, v112, s74
    v_perm_b32 v114, v114, v112, s75
    v_perm_b32 v112, v115, v113, s74
    v_perm_b32 v115, v115, v113, s75
    v_dot2c_f32_bf16_dpp v44, v82, v109 row_newbcast:4 row_mask:0xf bank_mask:0xf
    v_dot2c_f32_bf16_dpp v45, v82, v114 row_newbcast:4 row_mask:0xf bank_mask:0xf
    v_dot2c_f32_bf16_dpp v46, v82, v112 row_newbcast:4 row_mask:0xf bank_mask:0xf
    v_dot2c_f32_bf16_dpp v47, v82, v115 row_newbcast:4 row_mask:0xf bank_mask:0xf
    v_dot2c_f32_bf16_dpp v24, v83, v109 row_newbcast:4 row_mask:0xf bank_mask:0xf
    v_dot2c_f32_bf16_dpp v25, v83, v114 row_newbcast:4 row_mask:0xf bank_mask:0xf
    v_dot2c_f32_bf16_dpp v26, v83, v112 row_newbcast:4 row_mask:0xf bank_mask:0xf
    v_dot2c_f32_bf16_dpp v27, v83, v115 row_newbcast:4 row_mask:0xf bank_mask:0xf
    s_waitcnt vmcnt(11)
    v_perm_b32 v113, v118, v116, s74
    v_perm_b32 v118, v118, v116, s75
    v_perm_b32 v116, v119, v117, s74
    v_perm_b32 v119, v119, v117, s75
    v_dot2c_f32_bf16_dpp v44, v82, v113 row_newbcast:5 row_mask:0xf bank_mask:0xf
    v_dot2c_f32_bf16_dpp v45, v82, v118 row_newbcast:5 row_mask:0xf bank_mask:0xf
    v_dot2c_f32_bf16_dpp v46, v82, v116 row_newbcast:5 row_mask:0xf bank_mask:0xf
    v_dot2c_f32_bf16_dpp v47, v82, v119 row_newbcast:5 row_mask:0xf bank_mask:0xf
    v_dot2c_f32_bf16_dpp v24, v83, v113 row_newbcast:5 row_mask:0xf bank_mask:0xf
    v_dot2c_f32_bf16_dpp v25, v83, v118 row_newbcast:5 row_mask:0xf bank_mask:0xf
    v_dot2c_f32_bf16_dpp v26, v83, v116 row_newbcast:5 row_mask:0xf bank_mask:0xf
    v_dot2c_f32_bf16_dpp v27, v83, v119 row_newbcast:5 row_mask:0xf bank_mask:0xf
    s_waitcnt vmcnt(9)
    v_perm_b32 v117, v122, v120, s74
    v_perm_b32 v122, v122, v120, s75
    v_perm_b32 v120, v123, v121, s74
    v_perm_b32 v123, v123, v121, s75
    v_dot2c_f32_bf16_dpp v44, v82, v117 row_newbcast:6 row_mask:0xf bank_mask:0xf
    v_dot2c_f32_bf16_dpp v45, v82, v122 row_newbcast:6 row_mask:0xf bank_mask:0xf
    v_dot2c_f32_bf16_dpp v46, v82, v120 row_newbcast:6 row_mask:0xf bank_mask:0xf
    v_dot2c_f32_bf16_dpp v47, v82, v123 row_newbcast:6 row_mask:0xf bank_mask:0xf
    v_dot2c_f32_bf16_dpp v24, v83, v117 row_newbcast:6 row_mask:0xf bank_mask:0xf
    v_dot2c_f32_bf16_dpp v25, v83, v122 row_newbcast:6 row_mask:0xf bank_mask:0xf
    v_dot2c_f32_bf16_dpp v26, v83, v120 row_newbcast:6 row_mask:0xf bank_mask:0xf
    v_dot2c_f32_bf16_dpp v27, v83, v123 row_newbcast:6 row_mask:0xf bank_mask:0xf
    s_waitcnt vmcnt(7)
    v_perm_b32 v121, v126, v124, s74
    v_perm_b32 v126, v126, v124, s75
    v_perm_b32 v124, v127, v125, s74
    v_perm_b32 v127, v127, v125, s75
    v_dot2c_f32_bf16_dpp v44, v82, v121 row_newbcast:7 row_mask:0xf bank_mask:0xf
    v_dot2c_f32_bf16_dpp v45, v82, v126 row_newbcast:7 row_mask:0xf bank_mask:0xf
    v_dot2c_f32_bf16_dpp v46, v82, v124 row_newbcast:7 row_mask:0xf bank_mask:0xf
    v_dot2c_f32_bf16_dpp v47, v82, v127 row_newbcast:7 row_mask:0xf bank_mask:0xf
    v_dot2c_f32_bf16_dpp v24, v83, v121 row_newbcast:7 row_mask:0xf bank_mask:0xf
    v_dot2c_f32_bf16_dpp v25, v83, v126 row_newbcast:7 row_mask:0xf bank_mask:0xf
    v_dot2c_f32_bf16_dpp v26, v83, v124 row_newbcast:7 row_mask:0xf bank_mask:0xf
    v_dot2c_f32_bf16_dpp v27, v83, v127 row_newbcast:7 row_mask:0xf bank_mask:0xf
    s_waitcnt vmcnt(5)
    v_perm_b32 v125, v130, v128, s74
    v_perm_b32 v130, v130, v128, s75
    v_perm_b32 v128, v131, v129, s74
    v_perm_b32 v131, v131, v129, s75
    v_dot2c_f32_bf16_dpp v44, v82, v125 row_newbcast:8 row_mask:0xf bank_mask:0xf
    v_dot2c_f32_bf16_dpp v45, v82, v130 row_newbcast:8 row_mask:0xf bank_mask:0xf
    v_dot2c_f32_bf16_dpp v46, v82, v128 row_newbcast:8 row_mask:0xf bank_mask:0xf
    v_dot2c_f32_bf16_dpp v47, v82, v131 row_newbcast:8 row_mask:0xf bank_mask:0xf
    v_dot2c_f32_bf16_dpp v24, v83, v125 row_newbcast:8 row_mask:0xf bank_mask:0xf
    v_dot2c_f32_bf16_dpp v25, v83, v130 row_newbcast:8 row_mask:0xf bank_mask:0xf
    v_dot2c_f32_bf16_dpp v26, v83, v128 row_newbcast:8 row_mask:0xf bank_mask:0xf
    v_dot2c_f32_bf16_dpp v27, v83, v131 row_newbcast:8 row_mask:0xf bank_mask:0xf
    s_waitcnt vmcnt(3)
    v_perm_b32 v129, v134, v132, s74
    v_perm_b32 v134, v134, v132, s75
    v_perm_b32 v132, v135, v133, s74
    v_perm_b32 v135, v135, v133, s75
    v_dot2c_f32_bf16_dpp v44, v82, v129 row_newbcast:9 row_mask:0xf bank_mask:0xf
    v_dot2c_f32_bf16_dpp v45, v82, v134 row_newbcast:9 row_mask:0xf bank_mask:0xf
    v_dot2c_f32_bf16_dpp v46, v82, v132 row_newbcast:9 row_mask:0xf bank_mask:0xf
    v_dot2c_f32_bf16_dpp v47, v82, v135 row_newbcast:9 row_mask:0xf bank_mask:0xf
    v_dot2c_f32_bf16_dpp v24, v83, v129 row_newbcast:9 row_mask:0xf bank_mask:0xf
    v_dot2c_f32_bf16_dpp v25, v83, v134 row_newbcast:9 row_mask:0xf bank_mask:0xf
    v_dot2c_f32_bf16_dpp v26, v83, v132 row_newbcast:9 row_mask:0xf bank_mask:0xf
    v_dot2c_f32_bf16_dpp v27, v83, v135 row_newbcast:9 row_mask:0xf bank_mask:0xf
    v_mul_f32 v20, v81, v44
    v_mul_f32 v21, v81, v45
    v_mul_f32 v22, v81, v46
    v_mul_f32 v23, v81, v47
    v_permlane32_swap_b32 v44, v46
    v_permlane32_swap_b32 v45, v47
    v_add_f32 v44, v44, v46
    v_add_f32 v45, v45, v47
    s_nop 1
    v_permlane16_swap_b32 v44, v45
    v_add_f32 v44, v44, v45
    v_permlane32_swap_b32 v24, v26
    v_permlane32_swap_b32 v25, v27
    v_add_f32 v24, v24, v26
    v_add_f32 v25, v25, v27
    s_nop 1
    v_permlane16_swap_b32 v24, v25
    v_add_f32 v24, v24, v25
    ds_write_b32 v16, v44 offset:2048
    ds_write_b32 v16, v24 offset:4096
    s_waitcnt lgkmcnt(0)
    s_cbranch_execz L_nb_28
    s_barrier
L_nb_28:
    v_add_u32 v52, 2048, v18
    v_add_u32 v53, 4096, v18
    ds_read2st64_b32 v[44:45], v52 offset0:0 offset1:1
    ds_read2st64_b32 v[46:47], v52 offset0:2 offset1:3
    ds_read2st64_b32 v[48:49], v52 offset0:4 offset1:5
    ds_read2st64_b32 v[50:51], v52 offset0:6 offset1:7
    s_waitcnt lgkmcnt(3)
    v_add_f32 v44, v44, v45
    s_waitcnt lgkmcnt(2)
    v_add_f32 v46, v46, v47
    v_add_f32 v44, v44, v46
    s_waitcnt lgkmcnt(1)
    v_add_f32 v48, v48, v49
    s_waitcnt lgkmcnt(0)
    v_add_f32 v50, v50, v51
    v_add_f32 v48, v48, v50
    v_add_f32 v44, v44, v48
    v_mov_b32 v86, v44
    ds_read2st64_b32 v[44:45], v53 offset0:0 offset1:1
    ds_read2st64_b32 v[46:47], v53 offset0:2 offset1:3
    ds_read2st64_b32 v[48:49], v53 offset0:4 offset1:5
    ds_read2st64_b32 v[50:51], v53 offset0:6 offset1:7
    s_waitcnt lgkmcnt(3)
    v_add_f32 v44, v44, v45
    s_waitcnt lgkmcnt(2)
    v_add_f32 v46, v46, v47
    v_add_f32 v44, v44, v46
    s_waitcnt lgkmcnt(1)
    v_add_f32 v48, v48, v49
    s_waitcnt lgkmcnt(0)
    v_add_f32 v50, v50, v51
    v_add_f32 v48, v48, v50
    v_add_f32 v44, v44, v48
    v_mov_b32 v87, v44
    s_mov_b64 exec, s[72:73]
    s_cbranch_execz L_pdone_26
    s_branch L_pw_25
L_poll_24:
    buffer_load_dwordx4 v[28:31], v75, s[52:55], s14 offen sc1
    buffer_load_dwordx4 v[32:35], v75, s[52:55], s14 offen offset:1024 sc1
    buffer_load_dwordx4 v[36:39], v77, s[52:55], s14 offen offset:2048 sc1
L_pw_25:
    s_waitcnt vmcnt(0)
    v_max3_u32 v68, v28, v29, v30
    v_max3_u32 v68, v68, v31, v32
    v_max3_u32 v68, v68, v33, v34
    v_max3_u32 v68, v68, v35, v36
    v_max3_u32 v68, v68, v37, v38
    v_max_u32 v68, v68, v39
    v_cmp_eq_u32 vcc, -1, v68
    s_nop 0
    s_cbranch_vccz L_pdone_26
    s_cmp_eq_u32 s8, 0
    s_cbranch_scc1 L_pdone_26
    s_sub_u32 s8, s8, 1
    s_mov_b64 exec, vcc
    s_branch L_poll_24
L_pdone_26:
    s_mov_b64 exec, s[62:63]
    ds_write_b128 v76, v[28:31]
    ds_write_b128 v76, v[32:35] offset:1024
    s_and_b32 exec_lo, s62, 0xffffffff
    s_and_b32 exec_hi, s62, 0x0
    ds_write_b128 v76, v[36:39] offset:2048
    s_mov_b64 exec, s[62:63]
    s_waitcnt lgkmcnt(0)
    s_cbranch_execz L_nb_29
    s_barrier
L_nb_29:
    s_and_b32 exec_lo, s62, 0x3ff03ff
    s_and_b32 exec_hi, s62, 0x3ff03ff
    ds_read2st64_b64 v[28:31], v4 offset0:0 offset1:5
    ds_read2st64_b64 v[32:35], v4 offset0:10 offset1:15
    ds_read2st64_b64 v[36:39], v4 offset0:20 offset1:25
    ds_read2st64_b64 v[40:43], v4 offset0:30 offset1:35
    s_waitcnt lgkmcnt(3)
    v_pk_add_f32 v[28:29], v[28:29], v[30:31]
    s_waitcnt lgkmcnt(2)
    v_pk_add_f32 v[32:33], v[32:33], v[34:35]
    v_pk_add_f32 v[28:29], v[28:29], v[32:33]
    s_waitcnt lgkmcnt(1)
    v_pk_add_f32 v[36:37], v[36:37], v[38:39]
    s_waitcnt lgkmcnt(0)
    v_pk_add_f32 v[40:41], v[40:41], v[42:43]
    v_pk_add_f32 v[36:37], v[36:37], v[40:41]
    v_pk_add_f32 v[28:29], v[28:29], v[36:37]
    v_cvt_pk_bf16_f32 v68, v28, v29
    v_lshlrev_b32 v28, 16, v68
    v_and_b32 v29, s76, v68
    v_pk_mul_f32 v[28:29], v[28:29], v[6:7]
    v_cvt_pk_bf16_f32 v68, v28, v29
    v_lshlrev_b32 v28, 16, v68
    v_and_b32 v29, s76, v68
    v_pk_add_f32 v[28:29], v[28:29], v[12:13]
    v_cvt_pk_bf16_f32 v68, v28, v29
    v_lshlrev_b32 v28, 16, v68
    v_and_b32 v29, s76, v68
    v_pk_fma_f32 v[30:31], v[28:29], v[10:11], v[84:85] neg_lo:[0,0,1] neg_hi:[0,0,1]
    v_add_f32 v14, v28, v29
    v_cvt_pk_bf16_f32 v68, v30, v31
    v_mul_f32 v15, v28, v28
    v_fmac_f32 v15, v29, v29
    s_mov_b64 exec, s[62:63]
    v_dot2c_f32_bf16_dpp v20, v68, v92 row_newbcast:0 row_mask:0xf bank_mask:0xf
    v_dot2c_f32_bf16_dpp v21, v68, v98 row_newbcast:0 row_mask:0xf bank_mask:0xf
    v_dot2c_f32_bf16_dpp v22, v68, v96 row_newbcast:0 row_mask:0xf bank_mask:0xf
    v_dot2c_f32_bf16_dpp v23, v68, v99 row_newbcast:0 row_mask:0xf bank_mask:0xf
    v_permlane32_swap_b32 v14, v15
    v_dot2c_f32_bf16_dpp v20, v68, v97 row_newbcast:1 row_mask:0xf bank_mask:0xf
    v_dot2c_f32_bf16_dpp v21, v68, v102 row_newbcast:1 row_mask:0xf bank_mask:0xf
    v_dot2c_f32_bf16_dpp v22, v68, v100 row_newbcast:1 row_mask:0xf bank_mask:0xf
    v_dot2c_f32_bf16_dpp v23, v68, v103 row_newbcast:1 row_mask:0xf bank_mask:0xf
    v_add_f32 v14, v14, v15
    v_dot2c_f32_bf16_dpp v20, v68, v101 row_newbcast:2 row_mask:0xf bank_mask:0xf
    v_dot2c_f32_bf16_dpp v21, v68, v106 row_newbcast:2 row_mask:0xf bank_mask:0xf
    v_dot2c_f32_bf16_dpp v22, v68, v104 row_newbcast:2 row_mask:0xf bank_mask:0xf
    v_dot2c_f32_bf16_dpp v23, v68, v107 row_newbcast:2 row_mask:0xf bank_mask:0xf
    v_mov_b32 v15, v14
    v_dot2c_f32_bf16_dpp v20, v68, v105 row_newbcast:3 row_mask:0xf bank_mask:0xf
    v_dot2c_f32_bf16_dpp v21, v68, v110 row_newbcast:3 row_mask:0xf bank_mask:0xf
    v_dot2c_f32_bf16_dpp v22, v68, v108 row_newbcast:3 row_mask:0xf bank_mask:0xf
    v_dot2c_f32_bf16_dpp v23, v68, v111 row_newbcast:3 row_mask:0xf bank_mask:0xf
    v_permlane16_swap_b32 v15, v14
    v_dot2c_f32_bf16_dpp v20, v68, v109 row_newbcast:4 row_mask:0xf bank_mask:0xf
    v_dot2c_f32_bf16_dpp v21, v68, v114 row_newbcast:4 row_mask:0xf bank_mask:0xf
    v_dot2c_f32_bf16_dpp v22, v68, v112 row_newbcast:4 row_mask:0xf bank_mask:0xf
    v_dot2c_f32_bf16_dpp v23, v68, v115 row_newbcast:4 row_mask:0xf bank_mask:0xf
    v_add_f32 v14, v14, v15
    v_dot2c_f32_bf16_dpp v20, v68, v113 row_newbcast:5 row_mask:0xf bank_mask:0xf
    v_dot2c_f32_bf16_dpp v21, v68, v118 row_newbcast:5 row_mask:0xf bank_mask:0xf
    v_dot2c_f32_bf16_dpp v22, v68, v116 row_newbcast:5 row_mask:0xf bank_mask:0xf
    v_dot2c_f32_bf16_dpp v23, v68, v119 row_newbcast:5 row_mask:0xf bank_mask:0xf
    v_add_f32_dpp v14, v14, v14 row_ror:8 row_mask:0xf bank_mask:0xf
    v_dot2c_f32_bf16_dpp v20, v68, v117 row_newbcast:6 row_mask:0xf bank_mask:0xf
    v_dot2c_f32_bf16_dpp v21, v68, v122 row_newbcast:6 row_mask:0xf bank_mask:0xf
    v_dot2c_f32_bf16_dpp v22, v68, v120 row_newbcast:6 row_mask:0xf bank_mask:0xf
    v_dot2c_f32_bf16_dpp v23, v68, v123 row_newbcast:6 row_mask:0xf bank_mask:0xf
    v_add_f32_dpp v14, v14, v14 row_ror:4 row_mask:0xf bank_mask:0xf
    v_dot2c_f32_bf16_dpp v20, v68, v121 row_newbcast:7 row_mask:0xf bank_mask:0xf
    v_dot2c_f32_bf16_dpp v21, v68, v126 row_newbcast:7 row_mask:0xf bank_mask:0xf
    v_dot2c_f32_bf16_dpp v22, v68, v124 row_newbcast:7 row_mask:0xf bank_mask:0xf
    v_dot2c_f32_bf16_dpp v23, v68, v127 row_newbcast:7 row_mask:0xf bank_mask:0xf
    v_add_f32_dpp v14, v14, v14 quad_perm:[2,3,0,1] row_mask:0xf bank_mask:0xf
    v_dot2c_f32_bf16_dpp v20, v68, v125 row_newbcast:8 row_mask:0xf bank_mask:0xf
    v_dot2c_f32_bf16_dpp v21, v68, v130 row_newbcast:8 row_mask:0xf bank_mask:0xf
    v_dot2c_f32_bf16_dpp v22, v68, v128 row_newbcast:8 row_mask:0xf bank_mask:0xf
    v_dot2c_f32_bf16_dpp v23, v68, v131 row_newbcast:8 row_mask:0xf bank_mask:0xf
    v_add_f32_dpp v14, v14, v14 quad_perm:[1,0,3,2] row_mask:0xf bank_mask:0xf
    v_dot2c_f32_bf16_dpp v20, v68, v129 row_newbcast:9 row_mask:0xf bank_mask:0xf
    v_dot2c_f32_bf16_dpp v21, v68, v134 row_newbcast:9 row_mask:0xf bank_mask:0xf
    v_dot2c_f32_bf16_dpp v22, v68, v132 row_newbcast:9 row_mask:0xf bank_mask:0xf
    v_dot2c_f32_bf16_dpp v23, v68, v135 row_newbcast:9 row_mask:0xf bank_mask:0xf
    ds_write_b32 v72, v14 offset:4608
    s_nop 0
    v_permlane32_swap_b32 v20, v22
    v_permlane32_swap_b32 v21, v23
    v_add_f32 v20, v20, v22
    v_add_f32 v21, v21, v23
    s_nop 1
    v_permlane16_swap_b32 v20, v21
    v_add_f32 v20, v20, v21
    ds_write_b32 v16, v20
    v_lshlrev_b32 v4, 1, v2
    s_waitcnt lgkmcnt(0)
    s_cbranch_execz L_nb_30
    s_barrier
L_nb_30:
    s_cmp_lg_u32 s10, 0
    s_cbranch_scc1 L_fin
    ds_read_b32 v69, v73 offset:4608
    ds_read2st64_b32 v[28:29], v18 offset0:0 offset1:1
    ds_read2st64_b32 v[30:31], v18 offset0:2 offset1:3
    ds_read2st64_b32 v[32:33], v18 offset0:4 offset1:5
    ds_read2st64_b32 v[34:35], v18 offset0:6 offset1:7
    s_waitcnt lgkmcnt(4)
    v_add_f32_dpp v69, v69, v69 quad_perm:[1,0,3,2] row_mask:0xf bank_mask:0xf
    s_waitcnt lgkmcnt(2)
    v_add_f32 v28, v28, v29
    v_add_f32_dpp v69, v69, v69 quad_perm:[2,3,0,1] row_mask:0xf bank_mask:0xf
    v_add_f32 v30, v30, v31
    s_waitcnt lgkmcnt(0)
    v_add_f32_dpp v69, v69, v69 row_half_mirror row_mask:0xf bank_mask:0xf
    v_add_f32 v32, v32, v33
    v_add_f32 v34, v34, v35
    v_mul_f32_dpp v14, v69, v74 row_newbcast:0 row_mask:0xf bank_mask:0xf
    v_mul_f32_dpp v15, v69, v74 row_newbcast:8 row_mask:0xf bank_mask:0xf
    v_fma_f32 v15, -v14, v14, v15
    v_max_f32 v15, 0, v15
    v_cvt_pk_bf16_f32 v68, v14, v15
    v_and_b32 v15, s76, v68
    v_lshlrev_b32 v14, 16, v68
    v_add_f32 v15, 0x3727c5ac, v15
    v_cvt_pk_bf16_f32 v15, v15, v15
    v_and_b32 v15, s76, v15
    v_sqrt_f32 v15, v15
    v_add_f32 v28, v28, v30
    v_cvt_pk_bf16_f32 v15, v15, v15
    v_add_f32 v32, v32, v34
    v_and_b32 v15, s76, v15
    v_rcp_f32 v15, v15
    v_add_f32 v28, v28, v32
    v_fma_f32 v28, -v14, v86, v28
    v_fma_f32 v28, v28, v15, v87
    s_cmp_ge_u32 s40, 27
    s_cbranch_scc1 L_gu_up
    v_cvt_pk_bf16_f32 v28, v28, v28
    v_and_b32 v28, s76, v28
    v_mul_f32 v29, 0xbfb8aa3b, v28
    v_exp_f32 v29, v29
    s_nop 0
    v_add_f32 v29, 1.0, v29
    v_rcp_f32 v29, v29
    s_nop 0
    v_mul_f32 v28, v28, v29
L_gu_up:
    s_nop 1
    v_mov_b32_dpp v29, v28 quad_perm:[1,0,3,2] row_mask:0xf bank_mask:0xf
    v_cvt_pk_bf16_f32 v28, v28, v29
    v_min_u32 v28, 0xfffffffe, v28
    s_and_b32 exec_lo, s62, 0x55555555
    s_and_b32 exec_hi, s62, 0x55555555
    s_cbranch_execz L_nm_31
    buffer_store_dword v28, v4, s[52:55], s15 offen sc1
L_nm_31:
    s_branch L_fin
L_dn:
    s_mov_b32 s44, s32
    s_and_b32 s45, s33, 0xffff
    s_mov_b32 s46, 2211840
    s_mov_b32 s47, 0x20000
    s_lshl_b32 s12, s40, 5
    s_add_u32 s13, s12, 5120
    v_lshrrev_b32 v4, 1, v1
    v_mul_u32_u24 v4, 10240, v4
    v_and_b32 v5, 1, v1
    v_lshl_add_u32 v4, v5, 4, v4
    s_nop 0
    s_cbranch_execz L_nm_32
    buffer_load_dwordx4 v[96:99], v4, s[44:47], s12 offen offset:0
    buffer_load_dwordx4 v[100:103], v4, s[44:47], s12 offen offset:1280
    buffer_load_dwordx4 v[104:107], v4, s[44:47], s12 offen offset:2560
    buffer_load_dwordx4 v[108:111], v4, s[44:47], s12 offen offset:3840
    buffer_load_dwordx4 v[112:115], v4, s[44:47], s13 offen offset:0
    buffer_load_dwordx4 v[116:119], v4, s[44:47], s13 offen offset:1280
    buffer_load_dwordx4 v[120:123], v4, s[44:47], s13 offen offset:2560
    buffer_load_dwordx4 v[124:127], v4, s[44:47], s13 offen offset:3840
L_nm_32:
    v_lshrrev_b32 v16, 3, v2
    v_lshl_add_u32 v16, v5, 3, v16
    s_lshl_b32 s11, s10, 6
    s_add_u32 s11, s11, 4736
    v_lshl_add_u32 v16, v16, 2, s11
    v_lshlrev_b32 v17, 2, v2
    v_add_u32 v17, 4736, v17
    s_cmp_lg_u32 s10, 0
    s_cbranch_scc1 L_dn_x1done
    s_mov_b32 s48, s16
    s_and_b32 s49, s17, 0xffff
    s_mov_b32 s50, 1280
    s_mov_b32 s51, 0x20000
    v_lshrrev_b32 v4, 1, v3
    v_lshlrev_b32 v4, 2, v4
    s_add_u32 s13, s12, 245760
    s_lshl_b32 s15, s40, 6
    s_add_u32 s15, s15, 16384
    s_add_u32 s15, s15, s9
    s_cbranch_execz L_nm_33
    buffer_load_dword v30, v4, s[48:51], s12 offen
L_nm_33:
    s_mov_b64 s[72:73], exec
    s_cbranch_execz L_pdone_35
L_poll_34:
    buffer_load_dword v28, v4, s[52:55], s13 offen sc1
    buffer_load_dword v29, v4, s[52:55], s13 offen offset:3840 sc1
    s_waitcnt vmcnt(0)
    v_max_u32 v8, v28, v29
    v_cmp_eq_u32 vcc, -1, v8
    s_nop 0
    s_cbranch_vccz L_pdone_35
    s_cmp_eq_u32 s8, 0
    s_cbranch_scc1 L_pdone_35
    s_sub_u32 s8, s8, 1
    s_mov_b64 exec, vcc
    s_sleep 8
    s_branch L_poll_34
L_pdone_35:
    s_mov_b64 exec, s[72:73]
    v_cmp_eq_u32 vcc, 1, v5
    v_lshlrev_b32 v6, 16, v28
    v_and_b32 v7, s76, v28
    v_cndmask_b32 v12, v6, v7, vcc
    v_lshlrev_b32 v6, 16, v29
    v_and_b32 v7, s76, v29
    v_cndmask_b32 v13, v6, v7, vcc
    v_lshlrev_b32 v6, 16, v30
    v_and_b32 v7, s76, v30
    v_cndmask_b32 v14, v6, v7, vcc
    v_lshrrev_b32 v6, 4, v2
    v_add_u32 v6, 0, v6
    v_mul_u32_u24 v7, 11, v6
    v_lshrrev_b32 v7, 5, v7
    v_mul_u32_u24 v7, 8704, v7
    v_mul_u32_u24 v6, 2560, v6
    v_add_u32 v6, v6, v7
    v_lshl_add_u32 v10, v3, 2, v6
    v_lshrrev_b32 v6, 4, v2
    v_add_u32 v6, 4, v6
    v_mul_u32_u24 v7, 11, v6
    v_lshrrev_b32 v7, 5, v7
    v_mul_u32_u24 v7, 8704, v7
    v_mul_u32_u24 v6, 2560, v6
    v_add_u32 v6, v6, v7
    v_lshl_add_u32 v11, v3, 2, v6
    s_mov_b64 s[72:73], exec
    s_cbranch_execz L_pdone_37
L_poll_36:
    buffer_load_dword v28, v10, s[52:55], s15 offen sc1
    buffer_load_dword v29, v11, s[52:55], s15 offen sc1
    s_waitcnt vmcnt(0)
    v_max_u32 v6, v28, v29
    v_cmp_eq_u32 vcc, -1, v6
    s_nop 0
    s_cbranch_vccz L_pdone_37
    s_cmp_eq_u32 s8, 0
    s_cbranch_scc1 L_pdone_37
    s_sub_u32 s8, s8, 1
    s_mov_b64 exec, vcc
    s_sleep 2
    s_branch L_poll_36
L_pdone_37:
    s_mov_b64 exec, s[72:73]
    v_add_f32 v28, v28, v29
    v_mov_b32 v4, v28
    s_nop 1
    v_permlane16_swap_b32 v4, v28
    v_add_f32 v28, v28, v4
    v_mov_b32 v4, v28
    s_nop 1
    v_permlane32_swap_b32 v4, v28
    v_add_f32 v28, v28, v4
    v_cvt_pk_bf16_f32 v28, v28, v28
    v_and_b32 v28, s76, v28
    v_mul_f32 v28, v12, v28
    v_cvt_pk_bf16_f32 v28, v28, v28
    v_and_b32 v28, s76, v28
    v_add_f32 v14, v14, v28
    v_cvt_pk_bf16_f32 v14, v14, v14
    v_and_b32 v14, s76, v14
    s_cmp_lg_u32 s40, 0
    s_cbranch_scc1 L_dn_x1done
    s_mul_i32 s7, s7, 1664525
    s_add_u32 s7, s7, 1013904223
    s_and_b32 exec_lo, s62, 0x1
    s_and_b32 exec_hi, s62, 0x0
    v_mov_b32 v29, s7
    v_mov_b32 v4, 0
    s_nop 0
    s_cbranch_execz L_nm_38
    buffer_store_dword v29, v4, s[52:55], 0 offen sc1
L_nm_38:
    s_mov_b64 exec, s[62:63]
L_dn_x1done:
    s_mov_b32 s48, s38
    s_and_b32 s49, s39, 0xffff
    s_mov_b32 s50, 1280
    s_mov_b32 s51, 0x20000
    v_mov_b32 v28, 0
    v_mov_b32 v29, 0
    v_mov_b32 v30, 0
    v_mov_b32 v31, 0
    v_lshlrev_b32 v4, 3, v1
    s_add_u32 s13, s9, 65536
    v_lshlrev_b32 v9, 1, v2
    v_cmp_gt_u32 vcc, 432, v1
    s_mov_b64 exec, vcc
    s_mov_b64 s[72:73], exec
    s_cbranch_execz L_ps_42
    buffer_load_dwordx2 v[28:29], v4, s[52:55], s13 offen sc1
    buffer_load_dwordx2 v[30:31], v4, s[52:55], s13 offen offset:3456 sc1
    s_waitcnt vmcnt(2)
    s_branch L_ps_422
L_ps_42:
    s_waitcnt vmcnt(0)
L_ps_422:
    s_mov_b64 exec, s[62:63]
    v_perm_b32 v92, v100, v96, s74
    v_perm_b32 v100, v100, v96, s75
    v_perm_b32 v96, v101, v97, s74
    v_perm_b32 v101, v101, v97, s75
    v_perm_b32 v97, v102, v98, s74
    v_perm_b32 v102, v102, v98, s75
    v_perm_b32 v98, v103, v99, s74
    v_perm_b32 v103, v103, v99, s75
    v_perm_b32 v99, v108, v104, s74
    v_perm_b32 v108, v108, v104, s75
    v_perm_b32 v104, v109, v105, s74
    v_perm_b32 v109, v109, v105, s75
    v_perm_b32 v105, v110, v106, s74
    v_perm_b32 v110, v110, v106, s75
    v_perm_b32 v106, v111, v107, s74
    v_perm_b32 v111, v111, v107, s75
    v_perm_b32 v107, v116, v112, s74
    v_perm_b32 v116, v116, v112, s75
    v_perm_b32 v112, v117, v113, s74
    v_perm_b32 v117, v117, v113, s75
    v_perm_b32 v113, v118, v114, s74
    v_perm_b32 v118, v118, v114, s75
    v_perm_b32 v114, v119, v115, s74
    v_perm_b32 v119, v119, v115, s75
    v_perm_b32 v115, v124, v120, s74
    v_perm_b32 v124, v124, v120, s75
    v_perm_b32 v120, v125, v121, s74
    v_perm_b32 v125, v125, v121, s75
    v_perm_b32 v121, v126, v122, s74
    v_perm_b32 v126, v126, v122, s75
    v_perm_b32 v122, v127, v123, s74
    v_perm_b32 v127, v127, v123, s75
    s_mov_b64 exec, s[72:73]
    s_cbranch_execz L_pdone_41
    s_branch L_pw_40
L_poll_39:
    buffer_load_dwordx2 v[28:29], v4, s[52:55], s13 offen sc1
    buffer_load_dwordx2 v[30:31], v4, s[52:55], s13 offen offset:3456 sc1
L_pw_40:
    s_waitcnt vmcnt(0)
    v_max3_u32 v6, v28, v29, v30
    v_max_u32 v6, v6, v31
    v_cmp_eq_u32 vcc, -1, v6
    s_nop 0
    s_cbranch_vccz L_pdone_41
    s_cmp_eq_u32 s8, 0
    s_cbranch_scc1 L_pdone_41
    s_sub_u32 s8, s8, 1
    s_mov_b64 exec, vcc
    s_branch L_poll_39
L_pdone_41:
    s_mov_b64 exec, s[62:63]
    v_lshlrev_b32 v32, 16, v28
    v_and_b32 v33, s76, v28
    v_lshlrev_b32 v34, 16, v29
    v_and_b32 v35, s76, v29
    v_lshlrev_b32 v36, 16, v30
    v_and_b32 v37, s76, v30
    v_lshlrev_b32 v38, 16, v31
    v_and_b32 v39, s76, v31
    v_pk_mul_f32 v[32:33], v[32:33], v[36:37]
    v_pk_mul_f32 v[34:35], v[34:35], v[38:39]
    v_cvt_pk_bf16_f32 v28, v32, v33
    v_cvt_pk_bf16_f32 v29, v34, v35
    s_nop 0
    v_dot2c_f32_bf16_dpp v20, v28, v92 quad_perm:[0,0,2,2] row_mask:0xf bank_mask:0xf
    v_dot2c_f32_bf16_dpp v21, v28, v100 quad_perm:[0,0,2,2] row_mask:0xf bank_mask:0xf
    v_dot2c_f32_bf16_dpp v22, v28, v96 quad_perm:[0,0,2,2] row_mask:0xf bank_mask:0xf
    v_dot2c_f32_bf16_dpp v23, v28, v101 quad_perm:[0,0,2,2] row_mask:0xf bank_mask:0xf
    v_dot2c_f32_bf16_dpp v24, v28, v97 quad_perm:[0,0,2,2] row_mask:0xf bank_mask:0xf
    v_dot2c_f32_bf16_dpp v25, v28, v102 quad_perm:[0,0,2,2] row_mask:0xf bank_mask:0xf
    v_dot2c_f32_bf16_dpp v26, v28, v98 quad_perm:[0,0,2,2] row_mask:0xf bank_mask:0xf
    v_dot2c_f32_bf16_dpp v27, v28, v103 quad_perm:[0,0,2,2] row_mask:0xf bank_mask:0xf
    v_dot2c_f32_bf16_dpp v20, v29, v99 quad_perm:[0,0,2,2] row_mask:0xf bank_mask:0xf
    v_dot2c_f32_bf16_dpp v21, v29, v108 quad_perm:[0,0,2,2] row_mask:0xf bank_mask:0xf
    v_dot2c_f32_bf16_dpp v22, v29, v104 quad_perm:[0,0,2,2] row_mask:0xf bank_mask:0xf
    v_dot2c_f32_bf16_dpp v23, v29, v109 quad_perm:[0,0,2,2] row_mask:0xf bank_mask:0xf
    v_dot2c_f32_bf16_dpp v24, v29, v105 quad_perm:[0,0,2,2] row_mask:0xf bank_mask:0xf
    v_dot2c_f32_bf16_dpp v25, v29, v110 quad_perm:[0,0,2,2] row_mask:0xf bank_mask:0xf
    v_dot2c_f32_bf16_dpp v26, v29, v106 quad_perm:[0,0,2,2] row_mask:0xf bank_mask:0xf
    v_dot2c_f32_bf16_dpp v27, v29, v111 quad_perm:[0,0,2,2] row_mask:0xf bank_mask:0xf
    v_dot2c_f32_bf16_dpp v20, v28, v107 quad_perm:[1,1,3,3] row_mask:0xf bank_mask:0xf
    v_dot2c_f32_bf16_dpp v21, v28, v116 quad_perm:[1,1,3,3] row_mask:0xf bank_mask:0xf
    v_dot2c_f32_bf16_dpp v22, v28, v112 quad_perm:[1,1,3,3] row_mask:0xf bank_mask:0xf
    v_dot2c_f32_bf16_dpp v23, v28, v117 quad_perm:[1,1,3,3] row_mask:0xf bank_mask:0xf
    v_dot2c_f32_bf16_dpp v24, v28, v113 quad_perm:[1,1,3,3] row_mask:0xf bank_mask:0xf
    v_dot2c_f32_bf16_dpp v25, v28, v118 quad_perm:[1,1,3,3] row_mask:0xf bank_mask:0xf
    v_dot2c_f32_bf16_dpp v26, v28, v114 quad_perm:[1,1,3,3] row_mask:0xf bank_mask:0xf
    v_dot2c_f32_bf16_dpp v27, v28, v119 quad_perm:[1,1,3,3] row_mask:0xf bank_mask:0xf
    v_dot2c_f32_bf16_dpp v20, v29, v115 quad_perm:[1,1,3,3] row_mask:0xf bank_mask:0xf
    v_dot2c_f32_bf16_dpp v21, v29, v124 quad_perm:[1,1,3,3] row_mask:0xf bank_mask:0xf
    v_dot2c_f32_bf16_dpp v22, v29, v120 quad_perm:[1,1,3,3] row_mask:0xf bank_mask:0xf
    v_dot2c_f32_bf16_dpp v23, v29, v125 quad_perm:[1,1,3,3] row_mask:0xf bank_mask:0xf
    v_dot2c_f32_bf16_dpp v24, v29, v121 quad_perm:[1,1,3,3] row_mask:0xf bank_mask:0xf
    v_dot2c_f32_bf16_dpp v25, v29, v126 quad_perm:[1,1,3,3] row_mask:0xf bank_mask:0xf
    v_dot2c_f32_bf16_dpp v26, v29, v122 quad_perm:[1,1,3,3] row_mask:0xf bank_mask:0xf
    v_dot2c_f32_bf16_dpp v27, v29, v127 quad_perm:[1,1,3,3] row_mask:0xf bank_mask:0xf
    v_permlane32_swap_b32 v20, v24
    v_permlane32_swap_b32 v21, v25
    v_permlane32_swap_b32 v22, v26
    v_permlane32_swap_b32 v23, v27
    v_add_f32 v20, v20, v24
    v_add_f32 v21, v21, v25
    v_add_f32 v22, v22, v26
    v_add_f32 v23, v23, v27
    s_nop 0
    v_permlane16_swap_b32 v20, v22
    v_permlane16_swap_b32 v21, v23
    v_add_f32 v20, v20, v22
    v_add_f32 v21, v21, v23
    s_nop 0
    v_add_f32_dpp v15, v20, v20 row_ror:8 row_mask:0xf bank_mask:0x3
    s_nop 1
    v_add_f32_dpp v15, v21, v21 row_ror:8 row_mask:0xf bank_mask:0xc
    s_nop 1
    v_add_f32_dpp v15, v15, v15 row_shl:4 row_mask:0xf bank_mask:0x5
    s_nop 1
    v_add_f32_dpp v15, v15, v15 quad_perm:[2,3,0,1] row_mask:0xf bank_mask:0xf
    s_and_b32 exec_lo, s62, 0x3030303
    s_and_b32 exec_hi, s62, 0x3030303
    ds_write_b32 v16, v15
    s_mov_b64 exec, s[62:63]
    s_waitcnt lgkmcnt(0)
    s_cbranch_execz L_nb_43
    s_barrier
L_nb_43:
    s_cmp_lg_u32 s10, 0
    s_cbranch_scc1 L_fin
    s_and_b32 exec_lo, s62, 0xffff
    s_and_b32 exec_hi, s62, 0x0
    ds_read2_b32 v[28:29], v17 offset0:0 offset1:16
    ds_read2_b32 v[30:31], v17 offset0:32 offset1:48
    ds_read2_b32 v[32:33], v17 offset0:64 offset1:80
    ds_read2_b32 v[34:35], v17 offset0:96 offset1:112
    s_waitcnt lgkmcnt(3)
    v_add_f32 v28, v28, v29
    s_waitcnt lgkmcnt(2)
    v_add_f32 v30, v30, v31
    v_add_f32 v28, v28, v30
    s_waitcnt lgkmcnt(1)
    v_add_f32 v32, v32, v33
    s_waitcnt lgkmcnt(0)
    v_add_f32 v34, v34, v35
    v_add_f32 v32, v32, v34
    v_add_f32 v28, v28, v32
    v_cvt_pk_bf16_f32 v28, v28, v28
    v_and_b32 v28, s76, v28
    v_mul_f32 v28, v13, v28
    v_cvt_pk_bf16_f32 v28, v28, v28
    v_and_b32 v28, s76, v28
    v_add_f32 v28, v14, v28
    v_cvt_pk_bf16_f32 v28, v28, v28
    s_nop 0
    s_cbranch_execz L_nm_44
    buffer_store_short v28, v9, s[48:51], s12 offen
L_nm_44:
L_fin:
    s_cbranch_execz L_dry_ret
L_end:
    s_endpgm
L_help:
    s_setprio 3
    s_and_b32 s4, s2, 7
    s_lshr_b32 s5, s2, 3
    s_cmp_eq_u32 s3, 2
    s_cbranch_scc1 L_h2
    s_waitcnt lgkmcnt(0)
    s_load_dword s7, s[42:43], 0
    s_getpc_b64 s[72:73]
L_pc_45:
    s_lshl_b32 s11, s2, 2
    s_add_u32 s11, s11, role_tbl-L_pc_45
    s_load_dword s26, s[72:73], s11
    s_mov_b32 s52, s42
    s_and_b32 s53, s43, 0xffff
    s_mov_b32 s54, 786432
    s_mov_b32 s55, 0x20000
    s_mov_b32 s8, 400000
    s_mov_b32 s74, 0x05040100
    s_mov_b32 s75, 0x07060302
    s_mov_b32 s76, 0xffff0000
    s_mov_b64 s[62:63], -1
    s_cmp_eq_u32 s3, 1
    s_cbranch_scc1 L_h1
    s_cmp_eq_u32 s3, 3
    s_cbranch_scc1 L_h3
L_h0:
    s_mov_b32 s9, 0
    s_cmp_ge_u32 s5, 30
    s_cbranch_scc1 L_h0_none
L_h0_tile:
    s_mov_b32 s44, s36
    s_and_b32 s45, s37, 0xffff
    s_mov_b32 s46, 4915200
    s_mov_b32 s47, 0x20000
    s_mov_b32 s48, s34
    s_and_b32 s49, s35, 0xffff
    s_mov_b32 s50, 1280
    s_mov_b32 s51, 0x20000
    v_lshrrev_b32 v2, 4, v1
    v_mul_u32_u24 v2, 10, v2
    v_and_b32 v17, 15, v1
    v_add_u32 v17, v17, v2
    v_lshlrev_b32 v17, 2, v17
    s_mul_i32 s13, s4, 160
    v_lshlrev_b32 v16, 4, v1
    buffer_load_dword v17, v17, s[48:51], s13 offen
    s_mul_i32 s12, s4, 614400
    s_lshl_b32 s13, s5, 8
    s_add_u32 s12, s12, s13
    v_lshrrev_b32 v2, 4, v1
    v_mul_u32_u24 v2, 153600, v2
    v_and_b32 v3, 15, v1
    v_lshl_add_u32 v2, v3, 4, v2
    buffer_load_dwordx4 v[24:27], v2, s[44:47], s12 offen nt
    s_add_u32 s12, s12, 7680
    buffer_load_dwordx4 v[28:31], v2, s[44:47], s12 offen nt
    s_add_u32 s12, s12, 7680
    buffer_load_dwordx4 v[32:35], v2, s[44:47], s12 offen nt
    s_add_u32 s12, s12, 7680
    buffer_load_dwordx4 v[36:39], v2, s[44:47], s12 offen nt
    s_add_u32 s12, s12, 7680
    buffer_load_dwordx4 v[40:43], v2, s[44:47], s12 offen nt
    s_add_u32 s12, s12, 7680
    buffer_load_dwordx4 v[44:47], v2, s[44:47], s12 offen nt
    s_add_u32 s12, s12, 7680
    buffer_load_dwordx4 v[48:51], v2, s[44:47], s12 offen nt
    s_add_u32 s12, s12, 7680
    buffer_load_dwordx4 v[52:55], v2, s[44:47], s12 offen nt
    s_add_u32 s12, s12, 7680
    buffer_load_dwordx4 v[56:59], v2, s[44:47], s12 offen nt
    s_add_u32 s12, s12, 7680
    buffer_load_dwordx4 v[60:63], v2, s[44:47], s12 offen nt
    s_add_u32 s12, s12, 7680
    buffer_load_dwordx4 v[64:67], v2, s[44:47], s12 offen nt
    s_add_u32 s12, s12, 7680
    buffer_load_dwordx4 v[68:71], v2, s[44:47], s12 offen nt
    s_add_u32 s12, s12, 7680
    buffer_load_dwordx4 v[72:75], v2, s[44:47], s12 offen nt
    s_add_u32 s12, s12, 7680
    buffer_load_dwordx4 v[76:79], v2, s[44:47], s12 offen nt
    s_add_u32 s12, s12, 7680
    buffer_load_dwordx4 v[80:83], v2, s[44:47], s12 offen nt
    s_add_u32 s12, s12, 7680
    buffer_load_dwordx4 v[84:87], v2, s[44:47], s12 offen nt
    s_add_u32 s12, s12, 7680
    buffer_load_dwordx4 v[88:91], v2, s[44:47], s12 offen nt
    s_add_u32 s12, s12, 7680
    buffer_load_dwordx4 v[92:95], v2, s[44:47], s12 offen nt
    s_add_u32 s12, s12, 7680
    buffer_load_dwordx4 v[96:99], v2, s[44:47], s12 offen nt
    s_add_u32 s12, s12, 7680
    buffer_load_dwordx4 v[100:103], v2, s[44:47], s12 offen nt
    s_cmp_ge_u32 s2, 80
    s_cbranch_scc1 L_h0_np
    v_mov_b32 v120, -1
    v_mov_b32 v121, -1
    v_mov_b32 v122, -1
    v_mov_b32 v123, -1
    s_mul_i32 s13, s2, 3072
    s_add_u32 s13, s13, 16384
    buffer_store_dwordx4 v[120:123], v16, s[52:55], s13 offen offset:0 sc1
    buffer_store_dwordx4 v[120:123], v16, s[52:55], s13 offen offset:1024 sc1
    buffer_store_dwordx4 v[120:123], v16, s[52:55], s13 offen offset:2048 sc1
L_h0_np:
    s_barrier
    s_waitcnt lgkmcnt(0)
    s_mul_i32 s7, s7, 1664525
    s_add_u32 s7, s7, 1013904223
L_h0_p2:
    v_and_b32 v3, 15, v0
    v_mov_b32 v4, 0xffff
    v_mov_b32 v5, 0xffff0000
    v_cmp_eq_u32 vcc, 0, v3
    s_nop 1
    v_cndmask_b32 v8, 0, v4, vcc
    v_cmp_eq_u32 vcc, 1, v3
    s_nop 1
    v_cndmask_b32 v8, v8, v5, vcc
    v_cmp_eq_u32 vcc, 2, v3
    s_nop 1
    v_cndmask_b32 v9, 0, v4, vcc
    v_cmp_eq_u32 vcc, 3, v3
    s_nop 1
    v_cndmask_b32 v9, v9, v5, vcc
    v_cmp_eq_u32 vcc, 4, v3
    s_nop 1
    v_cndmask_b32 v10, 0, v4, vcc
    v_cmp_eq_u32 vcc, 5, v3
    s_nop 1
    v_cndmask_b32 v10, v10, v5, vcc
    v_cmp_eq_u32 vcc, 6, v3
    s_nop 1
    v_cndmask_b32 v11, 0, v4, vcc
    v_cmp_eq_u32 vcc, 7, v3
    s_nop 1
    v_cndmask_b32 v11, v11, v5, vcc
    v_mov_b32 v12, 0
    v_mov_b32 v13, 0
    v_mov_b32 v14, 0
    v_mov_b32 v15, 0
    s_mul_i32 s15, s4, 30720
    s_lshl_b32 s13, s5, 10
    s_add_u32 s15, s15, s13
    s_add_u32 s15, s15, 262144
    s_waitcnt vmcnt(20)
    v_and_b32 v18, s76, v17
    v_lshlrev_b32 v17, 16, v17
    v_mul_f32 v2, 0xbfb8aa3b, v17
    v_exp_f32 v2, v2
    s_nop 0
    v_add_f32 v2, 1.0, v2
    v_rcp_f32 v2, v2
    s_nop 0
    v_mul_f32 v17, v17, v2
    v_mul_f32 v3, 0xbfb8aa3b, v18
    v_exp_f32 v3, v3
    s_nop 0
    v_add_f32 v3, 1.0, v3
    v_rcp_f32 v3, v3
    s_nop 0
    v_mul_f32 v18, v18, v3
    v_cvt_pk_bf16_f32 v17, v17, v17
    v_cvt_pk_bf16_f32 v18, v18, v18
    s_nop 0
    v_and_b32_dpp v112, v17, v8 row_newbcast:0 row_mask:0xf bank_mask:0xf
    v_and_b32_dpp v113, v17, v9 row_newbcast:0 row_mask:0xf bank_mask:0xf
    v_and_b32_dpp v114, v17, v10 row_newbcast:0 row_mask:0xf bank_mask:0xf
    v_and_b32_dpp v115, v17, v11 row_newbcast:0 row_mask:0xf bank_mask:0xf
    s_waitcnt vmcnt(19)
    v_mov_b32 v125, s7
    v_mfma_f32_16x16x32_bf16 v[12:15], v[112:115], v[24:27], v[12:15]
    v_and_b32_dpp v116, v18, v8 row_newbcast:0 row_mask:0xf bank_mask:0xf
    v_and_b32_dpp v117, v18, v9 row_newbcast:0 row_mask:0xf bank_mask:0xf
    v_and_b32_dpp v118, v18, v10 row_newbcast:0 row_mask:0xf bank_mask:0xf
    v_and_b32_dpp v119, v18, v11 row_newbcast:0 row_mask:0xf bank_mask:0xf
    s_waitcnt vmcnt(18)
    v_mov_b32 v127, s7
    v_mfma_f32_16x16x32_bf16 v[12:15], v[116:119], v[28:31], v[12:15]
    v_and_b32_dpp v112, v17, v8 row_newbcast:1 row_mask:0xf bank_mask:0xf
    v_and_b32_dpp v113, v17, v9 row_newbcast:1 row_mask:0xf bank_mask:0xf
    v_and_b32_dpp v114, v17, v10 row_newbcast:1 row_mask:0xf bank_mask:0xf
    v_and_b32_dpp v115, v17, v11 row_newbcast:1 row_mask:0xf bank_mask:0xf
    s_waitcnt vmcnt(17)
    s_nop 0
    v_mfma_f32_16x16x32_bf16 v[12:15], v[112:115], v[32:35], v[12:15]
    v_and_b32_dpp v116, v18, v8 row_newbcast:1 row_mask:0xf bank_mask:0xf
    v_and_b32_dpp v117, v18, v9 row_newbcast:1 row_mask:0xf bank_mask:0xf
    v_and_b32_dpp v118, v18, v10 row_newbcast:1 row_mask:0xf bank_mask:0xf
    v_and_b32_dpp v119, v18, v11 row_newbcast:1 row_mask:0xf bank_mask:0xf
    s_waitcnt vmcnt(16)
    s_nop 0
    v_mfma_f32_16x16x32_bf16 v[12:15], v[116:119], v[36:39], v[12:15]
    v_and_b32_dpp v112, v17, v8 row_newbcast:2 row_mask:0xf bank_mask:0xf
    v_and_b32_dpp v113, v17, v9 row_newbcast:2 row_mask:0xf bank_mask:0xf
    v_and_b32_dpp v114, v17, v10 row_newbcast:2 row_mask:0xf bank_mask:0xf
    v_and_b32_dpp v115, v17, v11 row_newbcast:2 row_mask:0xf bank_mask:0xf
    s_waitcnt vmcnt(15)
    s_nop 0
    v_mfma_f32_16x16x32_bf16 v[12:15], v[112:115], v[40:43], v[12:15]
    v_and_b32_dpp v116, v18, v8 row_newbcast:2 row_mask:0xf bank_mask:0xf
    v_and_b32_dpp v117, v18, v9 row_newbcast:2 row_mask:0xf bank_mask:0xf
    v_and_b32_dpp v118, v18, v10 row_newbcast:2 row_mask:0xf bank_mask:0xf
    v_and_b32_dpp v119, v18, v11 row_newbcast:2 row_mask:0xf bank_mask:0xf
    s_waitcnt vmcnt(14)
    s_nop 0
    v_mfma_f32_16x16x32_bf16 v[12:15], v[116:119], v[44:47], v[12:15]
    v_and_b32_dpp v112, v17, v8 row_newbcast:3 row_mask:0xf bank_mask:0xf
    v_and_b32_dpp v113, v17, v9 row_newbcast:3 row_mask:0xf bank_mask:0xf
    v_and_b32_dpp v114, v17, v10 row_newbcast:3 row_mask:0xf bank_mask:0xf
    v_and_b32_dpp v115, v17, v11 row_newbcast:3 row_mask:0xf bank_mask:0xf
    s_waitcnt vmcnt(13)
    s_nop 0
    v_mfma_f32_16x16x32_bf16 v[12:15], v[112:115], v[48:51], v[12:15]
    v_and_b32_dpp v116, v18, v8 row_newbcast:3 row_mask:0xf bank_mask:0xf
    v_and_b32_dpp v117, v18, v9 row_newbcast:3 row_mask:0xf bank_mask:0xf
    v_and_b32_dpp v118, v18, v10 row_newbcast:3 row_mask:0xf bank_mask:0xf
    v_and_b32_dpp v119, v18, v11 row_newbcast:3 row_mask:0xf bank_mask:0xf
    s_waitcnt vmcnt(12)
    s_nop 0
    v_mfma_f32_16x16x32_bf16 v[12:15], v[116:119], v[52:55], v[12:15]
    v_and_b32_dpp v112, v17, v8 row_newbcast:4 row_mask:0xf bank_mask:0xf
    v_and_b32_dpp v113, v17, v9 row_newbcast:4 row_mask:0xf bank_mask:0xf
    v_and_b32_dpp v114, v17, v10 row_newbcast:4 row_mask:0xf bank_mask:0xf
    v_and_b32_dpp v115, v17, v11 row_newbcast:4 row_mask:0xf bank_mask:0xf
    s_waitcnt vmcnt(11)
    s_nop 0
    v_mfma_f32_16x16x32_bf16 v[12:15], v[112:115], v[56:59], v[12:15]
    v_and_b32_dpp v116, v18, v8 row_newbcast:4 row_mask:0xf bank_mask:0xf
    v_and_b32_dpp v117, v18, v9 row_newbcast:4 row_mask:0xf bank_mask:0xf
    v_and_b32_dpp v118, v18, v10 row_newbcast:4 row_mask:0xf bank_mask:0xf
    v_and_b32_dpp v119, v18, v11 row_newbcast:4 row_mask:0xf bank_mask:0xf
    s_waitcnt vmcnt(10)
    s_nop 0
    v_mfma_f32_16x16x32_bf16 v[12:15], v[116:119], v[60:63], v[12:15]
    v_and_b32_dpp v112, v17, v8 row_newbcast:5 row_mask:0xf bank_mask:0xf
    v_and_b32_dpp v113, v17, v9 row_newbcast:5 row_mask:0xf bank_mask:0xf
    v_and_b32_dpp v114, v17, v10 row_newbcast:5 row_mask:0xf bank_mask:0xf
    v_and_b32_dpp v115, v17, v11 row_newbcast:5 row_mask:0xf bank_mask:0xf
    s_waitcnt vmcnt(9)
    s_nop 0
    v_mfma_f32_16x16x32_bf16 v[12:15], v[112:115], v[64:67], v[12:15]
    v_and_b32_dpp v116, v18, v8 row_newbcast:5 row_mask:0xf bank_mask:0xf
    v_and_b32_dpp v117, v18, v9 row_newbcast:5 row_mask:0xf bank_mask:0xf
    v_and_b32_dpp v118, v18, v10 row_newbcast:5 row_mask:0xf bank_mask:0xf
    v_and_b32_dpp v119, v18, v11 row_newbcast:5 row_mask:0xf bank_mask:0xf
    s_waitcnt vmcnt(8)
    s_nop 0
    v_mfma_f32_16x16x32_bf16 v[12:15], v[116:119], v[68:71], v[12:15]
    v_and_b32_dpp v112, v17, v8 row_newbcast:6 row_mask:0xf bank_mask:0xf
    v_and_b32_dpp v113, v17, v9 row_newbcast:6 row_mask:0xf bank_mask:0xf
    v_and_b32_dpp v114, v17, v10 row_newbcast:6 row_mask:0xf bank_mask:0xf
    v_and_b32_dpp v115, v17, v11 row_newbcast:6 row_mask:0xf bank_mask:0xf
    s_waitcnt vmcnt(7)
    s_nop 0
    v_mfma_f32_16x16x32_bf16 v[12:15], v[112:115], v[72:75], v[12:15]
    v_and_b32_dpp v116, v18, v8 row_newbcast:6 row_mask:0xf bank_mask:0xf
    v_and_b32_dpp v117, v18, v9 row_newbcast:6 row_mask:0xf bank_mask:0xf
    v_and_b32_dpp v118, v18, v10 row_newbcast:6 row_mask:0xf bank_mask:0xf
    v_and_b32_dpp v119, v18, v11 row_newbcast:6 row_mask:0xf bank_mask:0xf
    s_waitcnt vmcnt(6)
    s_nop 0
    v_mfma_f32_16x16x32_bf16 v[12:15], v[116:119], v[76:79], v[12:15]
    v_and_b32_dpp v112, v17, v8 row_newbcast:7 row_mask:0xf bank_mask:0xf
    v_and_b32_dpp v113, v17, v9 row_newbcast:7 row_mask:0xf bank_mask:0xf
    v_and_b32_dpp v114, v17, v10 row_newbcast:7 row_mask:0xf bank_mask:0xf
    v_and_b32_dpp v115, v17, v11 row_newbcast:7 row_mask:0xf bank_mask:0xf
    s_waitcnt vmcnt(5)
    s_nop 0
    v_mfma_f32_16x16x32_bf16 v[12:15], v[112:115], v[80:83], v[12:15]
    v_and_b32_dpp v116, v18, v8 row_newbcast:7 row_mask:0xf bank_mask:0xf
    v_and_b32_dpp v117, v18, v9 row_newbcast:7 row_mask:0xf bank_mask:0xf
    v_and_b32_dpp v118, v18, v10 row_newbcast:7 row_mask:0xf bank_mask:0xf
    v_and_b32_dpp v119, v18, v11 row_newbcast:7 row_mask:0xf bank_mask:0xf
    s_waitcnt vmcnt(4)
    s_nop 0
    v_mfma_f32_16x16x32_bf16 v[12:15], v[116:119], v[84:87], v[12:15]
    v_and_b32_dpp v112, v17, v8 row_newbcast:8 row_mask:0xf bank_mask:0xf
    v_and_b32_dpp v113, v17, v9 row_newbcast:8 row_mask:0xf bank_mask:0xf
    v_and_b32_dpp v114, v17, v10 row_newbcast:8 row_mask:0xf bank_mask:0xf
    v_and_b32_dpp v115, v17, v11 row_newbcast:8 row_mask:0xf bank_mask:0xf
    s_waitcnt vmcnt(3)
    s_nop 0
    v_mfma_f32_16x16x32_bf16 v[12:15], v[112:115], v[88:91], v[12:15]
    v_and_b32_dpp v116, v18, v8 row_newbcast:8 row_mask:0xf bank_mask:0xf
    v_and_b32_dpp v117, v18, v9 row_newbcast:8 row_mask:0xf bank_mask:0xf
    v_and_b32_dpp v118, v18, v10 row_newbcast:8 row_mask:0xf bank_mask:0xf
    v_and_b32_dpp v119, v18, v11 row_newbcast:8 row_mask:0xf bank_mask:0xf
    s_waitcnt vmcnt(2)
    s_nop 0
    v_mfma_f32_16x16x32_bf16 v[12:15], v[116:119], v[92:95], v[12:15]
    v_and_b32_dpp v112, v17, v8 row_newbcast:9 row_mask:0xf bank_mask:0xf
    v_and_b32_dpp v113, v17, v9 row_newbcast:9 row_mask:0xf bank_mask:0xf
    v_and_b32_dpp v114, v17, v10 row_newbcast:9 row_mask:0xf bank_mask:0xf
    v_and_b32_dpp v115, v17, v11 row_newbcast:9 row_mask:0xf bank_mask:0xf
    s_waitcnt vmcnt(1)
    s_nop 0
    v_mfma_f32_16x16x32_bf16 v[12:15], v[112:115], v[96:99], v[12:15]
    v_and_b32_dpp v116, v18, v8 row_newbcast:9 row_mask:0xf bank_mask:0xf
    v_and_b32_dpp v117, v18, v9 row_newbcast:9 row_mask:0xf bank_mask:0xf
    v_and_b32_dpp v118, v18, v10 row_newbcast:9 row_mask:0xf bank_mask:0xf
    v_and_b32_dpp v119, v18, v11 row_newbcast:9 row_mask:0xf bank_mask:0xf
    s_waitcnt vmcnt(0)
    s_nop 0
    v_mfma_f32_16x16x32_bf16 v[12:15], v[116:119], v[100:103], v[12:15]
    s_nop 7
    v_permlane32_swap_b32 v12, v14
    v_permlane32_swap_b32 v13, v15
    v_mov_b32 v124, v12
    v_mov_b32 v126, v13
    buffer_store_dwordx4 v[124:127], v16, s[52:55], s15 offen sc1
    s_waitcnt vmcnt(0)
    s_branch L_h0_flag
L_h0_none:
    s_barrier
    s_waitcnt lgkmcnt(0)
    s_mul_i32 s7, s7, 1664525
    s_add_u32 s7, s7, 1013904223
L_h0_flag:
    v_mov_b32 v2, 0
    ds_write_b32 v2, v2 offset:344
    s_branch L_hend
L_h1:
    s_mov_b32 s44, s22
    s_and_b32 s45, s23, 0xffff
    s_mov_b32 s46, 5242880
    s_mov_b32 s47, 0x20000
    s_mov_b32 s56, s16
    s_and_b32 s57, s17, 0xffff
    s_mov_b32 s58, 1280
    s_mov_b32 s59, 0x20000
    s_and_b32 s14, s2, 7
    s_mul_i32 s13, s14, 40
    v_lshrrev_b32 v2, 4, v1
    v_mul_u32_u24 v2, 10, v2
    v_and_b32 v19, 15, v1
    v_add_u32 v19, v19, v2
    v_add_u32 v19, s13, v19
    v_and_b32 v2, 15, v19
    v_bfe_u32 v3, v19, 4, 1
    v_lshlrev_b32 v2, 2, v2
    v_lshl_add_u32 v2, v3, 1, v2
    v_bfe_u32 v3, v19, 5, 1
    v_and_b32 v21, 0xffc0, v19
    v_add3_u32 v21, v21, v2, v3
    v_lshlrev_b32 v17, 2, v21
    v_lshlrev_b32 v21, 14, v21
    v_lshlrev_b32 v4, 2, v1
    v_and_b32 v22, 15, v1
    v_lshlrev_b32 v22, 4, v22
    buffer_load_dword v17, v17, s[56:59], 0 offen
    buffer_load_dword v104, v4, s[56:59], 0 offen offset:0
    buffer_load_dword v105, v4, s[56:59], 0 offen offset:256
    buffer_load_dword v106, v4, s[56:59], 0 offen offset:512
    buffer_load_dword v107, v4, s[56:59], 0 offen offset:768
    buffer_load_dword v108, v4, s[56:59], 0 offen offset:1024
    s_lshr_b32 s12, s2, 3
    s_lshl_b32 s12, s12, 8
    s_add_u32 s13, s12, 8192
    v_add_u32_dpp v2, v21, v22 row_newbcast:0 row_mask:0xf bank_mask:0xf
    buffer_load_dwordx4 v[24:27], v2, s[44:47], s12 offen nt
    buffer_load_dwordx4 v[28:31], v2, s[44:47], s13 offen nt
    v_add_u32_dpp v3, v21, v22 row_newbcast:1 row_mask:0xf bank_mask:0xf
    buffer_load_dwordx4 v[32:35], v3, s[44:47], s12 offen nt
    buffer_load_dwordx4 v[36:39], v3, s[44:47], s13 offen nt
    v_add_u32_dpp v2, v21, v22 row_newbcast:2 row_mask:0xf bank_mask:0xf
    buffer_load_dwordx4 v[40:43], v2, s[44:47], s12 offen nt
    buffer_load_dwordx4 v[44:47], v2, s[44:47], s13 offen nt
    v_add_u32_dpp v3, v21, v22 row_newbcast:3 row_mask:0xf bank_mask:0xf
    buffer_load_dwordx4 v[48:51], v3, s[44:47], s12 offen nt
    buffer_load_dwordx4 v[52:55], v3, s[44:47], s13 offen nt
    v_add_u32_dpp v2, v21, v22 row_newbcast:4 row_mask:0xf bank_mask:0xf
    buffer_load_dwordx4 v[56:59], v2, s[44:47], s12 offen nt
    buffer_load_dwordx4 v[60:63], v2, s[44:47], s13 offen nt
    v_add_u32_dpp v3, v21, v22 row_newbcast:5 row_mask:0xf bank_mask:0xf
    buffer_load_dwordx4 v[64:67], v3, s[44:47], s12 offen nt
    buffer_load_dwordx4 v[68:71], v3, s[44:47], s13 offen nt
    v_add_u32_dpp v2, v21, v22 row_newbcast:6 row_mask:0xf bank_mask:0xf
    buffer_load_dwordx4 v[72:75], v2, s[44:47], s12 offen nt
    buffer_load_dwordx4 v[76:79], v2, s[44:47], s13 offen nt
    v_add_u32_dpp v3, v21, v22 row_newbcast:7 row_mask:0xf bank_mask:0xf
    buffer_load_dwordx4 v[80:83], v3, s[44:47], s12 offen nt
    buffer_load_dwordx4 v[84:87], v3, s[44:47], s13 offen nt
    v_add_u32_dpp v2, v21, v22 row_newbcast:8 row_mask:0xf bank_mask:0xf
    buffer_load_dwordx4 v[88:91], v2, s[44:47], s12 offen nt
    buffer_load_dwordx4 v[92:95], v2, s[44:47], s13 offen nt
    v_add_u32_dpp v3, v21, v22 row_newbcast:9 row_mask:0xf bank_mask:0xf
    buffer_load_dwordx4 v[96:99], v3, s[44:47], s12 offen nt
    buffer_load_dwordx4 v[100:103], v3, s[44:47], s13 offen nt
    s_barrier
    v_and_b32 v3, 15, v0
    v_mov_b32 v4, 0xffff
    v_mov_b32 v5, 0xffff0000
    v_cmp_eq_u32 vcc, 0, v3
    s_nop 1
    v_cndmask_b32 v8, 0, v4, vcc
    v_cmp_eq_u32 vcc, 1, v3
    s_nop 1
    v_cndmask_b32 v8, v8, v5, vcc
    v_cmp_eq_u32 vcc, 2, v3
    s_nop 1
    v_cndmask_b32 v9, 0, v4, vcc
    v_cmp_eq_u32 vcc, 3, v3
    s_nop 1
    v_cndmask_b32 v9, v9, v5, vcc
    v_cmp_eq_u32 vcc, 4, v3
    s_nop 1
    v_cndmask_b32 v10, 0, v4, vcc
    v_cmp_eq_u32 vcc, 5, v3
    s_nop 1
    v_cndmask_b32 v10, v10, v5, vcc
    v_cmp_eq_u32 vcc, 6, v3
    s_nop 1
    v_cndmask_b32 v11, 0, v4, vcc
    v_cmp_eq_u32 vcc, 7, v3
    s_nop 1
    v_cndmask_b32 v11, v11, v5, vcc
    v_mov_b32 v12, 0
    v_mov_b32 v13, 0
    v_mov_b32 v14, 0
    v_mov_b32 v15, 0
    v_lshlrev_b32 v16, 4, v1
    s_waitcnt lgkmcnt(0)
    s_mul_i32 s7, s7, 1664525
    s_add_u32 s7, s7, 1013904223
    s_waitcnt vmcnt(20)
    v_mov_b32 v110, 0
    v_mov_b32 v111, 0
    v_lshlrev_b32 v2, 16, v104
    v_and_b32 v3, s76, v104
    v_add_f32 v110, v110, v2
    v_fmac_f32 v111, v2, v2
    v_add_f32 v110, v110, v3
    v_fmac_f32 v111, v3, v3
    v_lshlrev_b32 v2, 16, v105
    v_and_b32 v3, s76, v105
    v_add_f32 v110, v110, v2
    v_fmac_f32 v111, v2, v2
    v_add_f32 v110, v110, v3
    v_fmac_f32 v111, v3, v3
    v_lshlrev_b32 v2, 16, v106
    v_and_b32 v3, s76, v106
    v_add_f32 v110, v110, v2
    v_fmac_f32 v111, v2, v2
    v_add_f32 v110, v110, v3
    v_fmac_f32 v111, v3, v3
    v_lshlrev_b32 v2, 16, v107
    v_and_b32 v3, s76, v107
    v_add_f32 v110, v110, v2
    v_fmac_f32 v111, v2, v2
    v_add_f32 v110, v110, v3
    v_fmac_f32 v111, v3, v3
    v_lshlrev_b32 v2, 16, v108
    v_and_b32 v3, s76, v108
    v_add_f32 v110, v110, v2
    v_fmac_f32 v111, v2, v2
    v_add_f32 v110, v110, v3
    v_fmac_f32 v111, v3, v3
    s_nop 0
    v_add_f32_dpp v110, v110, v110 quad_perm:[1,0,3,2] row_mask:0xf bank_mask:0xf
    v_add_f32_dpp v111, v111, v111 quad_perm:[1,0,3,2] row_mask:0xf bank_mask:0xf
    s_nop 0
    v_add_f32_dpp v110, v110, v110 quad_perm:[2,3,0,1] row_mask:0xf bank_mask:0xf
    v_add_f32_dpp v111, v111, v111 quad_perm:[2,3,0,1] row_mask:0xf bank_mask:0xf
    s_nop 0
    v_add_f32_dpp v110, v110, v110 row_ror:4 row_mask:0xf bank_mask:0xf
    v_add_f32_dpp v111, v111, v111 row_ror:4 row_mask:0xf bank_mask:0xf
    s_nop 0
    v_add_f32_dpp v110, v110, v110 row_ror:8 row_mask:0xf bank_mask:0xf
    v_add_f32_dpp v111, v111, v111 row_ror:8 row_mask:0xf bank_mask:0xf
    v_mov_b32 v2, v110
    v_mov_b32 v3, v111
    s_nop 0
    v_permlane16_swap_b32 v2, v110
    v_permlane16_swap_b32 v3, v111
    v_add_f32 v110, v110, v2
    v_add_f32 v111, v111, v3
    v_mov_b32 v2, v110
    v_mov_b32 v3, v111
    s_nop 0
    v_permlane32_swap_b32 v2, v110
    v_permlane32_swap_b32 v3, v111
    v_add_f32 v110, v110, v2
    v_add_f32 v111, v111, v3
    v_mul_f32 v110, 0x3acccccd, v110
    v_mul_f32 v111, 0x3acccccd, v111
    v_fma_f32 v111, -v110, v110, v111
    v_max_f32 v111, 0, v111
    v_cvt_pk_bf16_f32 v2, v110, v111
    v_lshlrev_b32 v110, 16, v2
    v_and_b32 v111, s76, v2
    v_add_f32 v111, 0x3727c5ac, v111
    v_cvt_pk_bf16_f32 v111, v111, v111
    v_and_b32 v111, s76, v111
    v_sqrt_f32 v111, v111
    s_nop 0
    v_cvt_pk_bf16_f32 v111, v111, v111
    v_and_b32 v111, s76, v111
    v_rcp_f32 v111, v111
    v_and_b32 v18, s76, v17
    v_lshlrev_b32 v17, 16, v17
    v_sub_f32 v17, v17, v110
    v_cvt_pk_bf16_f32 v17, v17, v17
    v_and_b32 v17, s76, v17
    v_mul_f32 v17, v17, v111
    v_cvt_pk_bf16_f32 v17, v17, v17
    v_and_b32 v17, s76, v17
    v_sub_f32 v18, v18, v110
    v_cvt_pk_bf16_f32 v18, v18, v18
    v_and_b32 v18, s76, v18
    v_mul_f32 v18, v18, v111
    v_cvt_pk_bf16_f32 v18, v18, v18
    v_and_b32 v18, s76, v18
    v_lshlrev_b32 v19, 4, v19
    v_add_u32 v20, 5120, v19
    s_mov_b32 s64, 262144
    s_mov_b32 s65, 292864
    s_mov_b32 s66, 323584
    s_mov_b32 s67, 354304
    s_mov_b32 s68, 385024
    s_mov_b32 s69, 415744
    s_mov_b32 s70, 446464
    s_mov_b32 s71, 477184
    s_lshl_b32 s15, s2, 10
    s_add_u32 s15, s15, 524288
    v_and_b32 v2, 1, v1
    v_lshlrev_b32 v2, 2, v2
    s_mov_b64 s[72:73], exec
L_poll_46:
    ds_read_b32 v3, v2 offset:344
    s_waitcnt lgkmcnt(0)
    v_cmp_eq_u32 vcc, -1, v3
    s_nop 0
    s_cbranch_vccz L_pdone_47
    s_cmp_eq_u32 s8, 0
    s_cbranch_scc1 L_pdone_47
    s_sub_u32 s8, s8, 1
    s_mov_b64 exec, vcc
    s_sleep 4
    s_branch L_poll_46
L_pdone_47:
    s_mov_b64 exec, s[72:73]
    s_mov_b32 exec_lo, 0x03ff03ff
    s_mov_b32 exec_hi, 0x03ff03ff
    s_mov_b64 s[72:73], exec
L_poll_48:
    buffer_load_dwordx4 v[104:107], v19, s[52:55], s64 offen sc1
    buffer_load_dwordx4 v[136:139], v20, s[52:55], s64 offen sc1
    buffer_load_dwordx4 v[108:111], v19, s[52:55], s65 offen sc1
    buffer_load_dwordx4 v[140:143], v20, s[52:55], s65 offen sc1
    buffer_load_dwordx4 v[112:115], v19, s[52:55], s66 offen sc1
    buffer_load_dwordx4 v[144:147], v20, s[52:55], s66 offen sc1
    buffer_load_dwordx4 v[116:119], v19, s[52:55], s67 offen sc1
    buffer_load_dwordx4 v[148:151], v20, s[52:55], s67 offen sc1
    buffer_load_dwordx4 v[120:123], v19, s[52:55], s68 offen sc1
    buffer_load_dwordx4 v[152:155], v20, s[52:55], s68 offen sc1
    buffer_load_dwordx4 v[124:127], v19, s[52:55], s69 offen sc1
    buffer_load_dwordx4 v[156:159], v20, s[52:55], s69 offen sc1
    buffer_load_dwordx4 v[128:131], v19, s[52:55], s70 offen sc1
    buffer_load_dwordx4 v[160:163], v20, s[52:55], s70 offen sc1
    buffer_load_dwordx4 v[132:135], v19, s[52:55], s71 offen sc1
    buffer_load_dwordx4 v[164:167], v20, s[52:55], s71 offen sc1
    s_waitcnt vmcnt(0)
    v_xor_b32 v2, s7, v105
    v_xor_b32 v3, s7, v107
    v_or_b32 v2, v2, v3
    v_xor_b32 v3, s7, v109
    v_or_b32 v2, v2, v3
    v_xor_b32 v3, s7, v111
    v_or_b32 v2, v2, v3
    v_xor_b32 v3, s7, v113
    v_or_b32 v2, v2, v3
    v_xor_b32 v3, s7, v115
    v_or_b32 v2, v2, v3
    v_xor_b32 v3, s7, v117
    v_or_b32 v2, v2, v3
    v_xor_b32 v3, s7, v119
    v_or_b32 v2, v2, v3
    v_xor_b32 v3, s7, v121
    v_or_b32 v2, v2, v3
    v_xor_b32 v3, s7, v123
    v_or_b32 v2, v2, v3
    v_xor_b32 v3, s7, v125
    v_or_b32 v2, v2, v3
    v_xor_b32 v3, s7, v127
    v_or_b32 v2, v2, v3
    v_xor_b32 v3, s7, v129
    v_or_b32 v2, v2, v3
    v_xor_b32 v3, s7, v131
    v_or_b32 v2, v2, v3
    v_xor_b32 v3, s7, v133
    v_or_b32 v2, v2, v3
    v_xor_b32 v3, s7, v135
    v_or_b32 v2, v2, v3
    v_xor_b32 v3, s7, v137
    v_or_b32 v2, v2, v3
    v_xor_b32 v3, s7, v139
    v_or_b32 v2, v2, v3
    v_xor_b32 v3, s7, v141
    v_or_b32 v2, v2, v3
    v_xor_b32 v3, s7, v143
    v_or_b32 v2, v2, v3
    v_xor_b32 v3, s7, v145
    v_or_b32 v2, v2, v3
    v_xor_b32 v3, s7, v147
    v_or_b32 v2, v2, v3
    v_xor_b32 v3, s7, v149
    v_or_b32 v2, v2, v3
    v_xor_b32 v3, s7, v151
    v_or_b32 v2, v2, v3
    v_xor_b32 v3, s7, v153
    v_or_b32 v2, v2, v3
    v_xor_b32 v3, s7, v155
    v_or_b32 v2, v2, v3
    v_xor_b32 v3, s7, v157
    v_or_b32 v2, v2, v3
    v_xor_b32 v3, s7, v159
    v_or_b32 v2, v2, v3
    v_xor_b32 v3, s7, v161
    v_or_b32 v2, v2, v3
    v_xor_b32 v3, s7, v163
    v_or_b32 v2, v2, v3
    v_xor_b32 v3, s7, v165
    v_or_b32 v2, v2, v3
    v_xor_b32 v3, s7, v167
    v_or_b32 v2, v2, v3
    v_cmp_ne_u32 vcc, 0, v2
    s_nop 0
    s_cbranch_vccz L_pdone_49
    s_cmp_eq_u32 s8, 0
    s_cbranch_scc1 L_pdone_49
    s_sub_u32 s8, s8, 1
    s_mov_b64 exec, vcc
    s_sleep 8
    s_branch L_poll_48
L_pdone_49:
    s_mov_b64 exec, s[72:73]
    v_add_f32 v104, v104, v120
    v_add_f32 v106, v106, v122
    v_add_f32 v108, v108, v124
    v_add_f32 v110, v110, v126
    v_add_f32 v112, v112, v128
    v_add_f32 v114, v114, v130
    v_add_f32 v116, v116, v132
    v_add_f32 v118, v118, v134
    v_add_f32 v104, v104, v112
    v_add_f32 v106, v106, v114
    v_add_f32 v108, v108, v116
    v_add_f32 v110, v110, v118
    v_add_f32 v104, v104, v108
    v_add_f32 v106, v106, v110
    v_cvt_pk_bf16_f32 v104, v104, v106
    v_add_f32 v136, v136, v152
    v_add_f32 v138, v138, v154
    v_add_f32 v140, v140, v156
    v_add_f32 v142, v142, v158
    v_add_f32 v144, v144, v160
    v_add_f32 v146, v146, v162
    v_add_f32 v148, v148, v164
    v_add_f32 v150, v150, v166
    v_add_f32 v136, v136, v144
    v_add_f32 v138, v138, v146
    v_add_f32 v140, v140, v148
    v_add_f32 v142, v142, v150
    v_add_f32 v136, v136, v140
    v_add_f32 v138, v138, v142
    v_cvt_pk_bf16_f32 v136, v136, v138
    v_lshlrev_b32 v2, 16, v136
    v_and_b32 v3, s76, v136
    v_add_f32 v2, 1.0, v2
    v_add_f32 v3, 1.0, v3
    v_cvt_pk_bf16_f32 v4, v2, v3
    v_lshlrev_b32 v2, 16, v4
    v_and_b32 v3, s76, v4
    v_mul_f32 v2, v17, v2
    v_mul_f32 v3, v18, v3
    v_cvt_pk_bf16_f32 v4, v2, v3
    v_lshlrev_b32 v2, 16, v4
    v_and_b32 v3, s76, v4
    v_lshlrev_b32 v17, 16, v104
    v_and_b32 v18, s76, v104
    v_add_f32 v17, v17, v2
    v_add_f32 v18, v18, v3
    v_cvt_pk_bf16_f32 v17, v17, v17
    v_cvt_pk_bf16_f32 v18, v18, v18
    s_mov_b64 exec, -1
    v_and_b32_dpp v112, v17, v8 row_newbcast:0 row_mask:0xf bank_mask:0xf
    v_and_b32_dpp v113, v17, v9 row_newbcast:0 row_mask:0xf bank_mask:0xf
    v_and_b32_dpp v114, v17, v10 row_newbcast:0 row_mask:0xf bank_mask:0xf
    v_and_b32_dpp v115, v17, v11 row_newbcast:0 row_mask:0xf bank_mask:0xf
    v_mov_b32 v121, s7
    s_nop 0
    v_mfma_f32_16x16x32_bf16 v[12:15], v[112:115], v[24:27], v[12:15]
    v_and_b32_dpp v116, v18, v8 row_newbcast:0 row_mask:0xf bank_mask:0xf
    v_and_b32_dpp v117, v18, v9 row_newbcast:0 row_mask:0xf bank_mask:0xf
    v_and_b32_dpp v118, v18, v10 row_newbcast:0 row_mask:0xf bank_mask:0xf
    v_and_b32_dpp v119, v18, v11 row_newbcast:0 row_mask:0xf bank_mask:0xf
    v_mov_b32 v123, s7
    s_nop 0
    v_mfma_f32_16x16x32_bf16 v[12:15], v[116:119], v[28:31], v[12:15]
    v_and_b32_dpp v112, v17, v8 row_newbcast:1 row_mask:0xf bank_mask:0xf
    v_and_b32_dpp v113, v17, v9 row_newbcast:1 row_mask:0xf bank_mask:0xf
    v_and_b32_dpp v114, v17, v10 row_newbcast:1 row_mask:0xf bank_mask:0xf
    v_and_b32_dpp v115, v17, v11 row_newbcast:1 row_mask:0xf bank_mask:0xf
    s_nop 1
    v_mfma_f32_16x16x32_bf16 v[12:15], v[112:115], v[32:35], v[12:15]
    v_and_b32_dpp v116, v18, v8 row_newbcast:1 row_mask:0xf bank_mask:0xf
    v_and_b32_dpp v117, v18, v9 row_newbcast:1 row_mask:0xf bank_mask:0xf
    v_and_b32_dpp v118, v18, v10 row_newbcast:1 row_mask:0xf bank_mask:0xf
    v_and_b32_dpp v119, v18, v11 row_newbcast:1 row_mask:0xf bank_mask:0xf
    s_nop 1
    v_mfma_f32_16x16x32_bf16 v[12:15], v[116:119], v[36:39], v[12:15]
    v_and_b32_dpp v112, v17, v8 row_newbcast:2 row_mask:0xf bank_mask:0xf
    v_and_b32_dpp v113, v17, v9 row_newbcast:2 row_mask:0xf bank_mask:0xf
    v_and_b32_dpp v114, v17, v10 row_newbcast:2 row_mask:0xf bank_mask:0xf
    v_and_b32_dpp v115, v17, v11 row_newbcast:2 row_mask:0xf bank_mask:0xf
    s_nop 1
    v_mfma_f32_16x16x32_bf16 v[12:15], v[112:115], v[40:43], v[12:15]
    v_and_b32_dpp v116, v18, v8 row_newbcast:2 row_mask:0xf bank_mask:0xf
    v_and_b32_dpp v117, v18, v9 row_newbcast:2 row_mask:0xf bank_mask:0xf
    v_and_b32_dpp v118, v18, v10 row_newbcast:2 row_mask:0xf bank_mask:0xf
    v_and_b32_dpp v119, v18, v11 row_newbcast:2 row_mask:0xf bank_mask:0xf
    s_nop 1
    v_mfma_f32_16x16x32_bf16 v[12:15], v[116:119], v[44:47], v[12:15]
    v_and_b32_dpp v112, v17, v8 row_newbcast:3 row_mask:0xf bank_mask:0xf
    v_and_b32_dpp v113, v17, v9 row_newbcast:3 row_mask:0xf bank_mask:0xf
    v_and_b32_dpp v114, v17, v10 row_newbcast:3 row_mask:0xf bank_mask:0xf
    v_and_b32_dpp v115, v17, v11 row_newbcast:3 row_mask:0xf bank_mask:0xf
    s_nop 1
    v_mfma_f32_16x16x32_bf16 v[12:15], v[112:115], v[48:51], v[12:15]
    v_and_b32_dpp v116, v18, v8 row_newbcast:3 row_mask:0xf bank_mask:0xf
    v_and_b32_dpp v117, v18, v9 row_newbcast:3 row_mask:0xf bank_mask:0xf
    v_and_b32_dpp v118, v18, v10 row_newbcast:3 row_mask:0xf bank_mask:0xf
    v_and_b32_dpp v119, v18, v11 row_newbcast:3 row_mask:0xf bank_mask:0xf
    s_nop 1
    v_mfma_f32_16x16x32_bf16 v[12:15], v[116:119], v[52:55], v[12:15]
    v_and_b32_dpp v112, v17, v8 row_newbcast:4 row_mask:0xf bank_mask:0xf
    v_and_b32_dpp v113, v17, v9 row_newbcast:4 row_mask:0xf bank_mask:0xf
    v_and_b32_dpp v114, v17, v10 row_newbcast:4 row_mask:0xf bank_mask:0xf
    v_and_b32_dpp v115, v17, v11 row_newbcast:4 row_mask:0xf bank_mask:0xf
    s_nop 1
    v_mfma_f32_16x16x32_bf16 v[12:15], v[112:115], v[56:59], v[12:15]
    v_and_b32_dpp v116, v18, v8 row_newbcast:4 row_mask:0xf bank_mask:0xf
    v_and_b32_dpp v117, v18, v9 row_newbcast:4 row_mask:0xf bank_mask:0xf
    v_and_b32_dpp v118, v18, v10 row_newbcast:4 row_mask:0xf bank_mask:0xf
    v_and_b32_dpp v119, v18, v11 row_newbcast:4 row_mask:0xf bank_mask:0xf
    s_nop 1
    v_mfma_f32_16x16x32_bf16 v[12:15], v[116:119], v[60:63], v[12:15]
    v_and_b32_dpp v112, v17, v8 row_newbcast:5 row_mask:0xf bank_mask:0xf
    v_and_b32_dpp v113, v17, v9 row_newbcast:5 row_mask:0xf bank_mask:0xf
    v_and_b32_dpp v114, v17, v10 row_newbcast:5 row_mask:0xf bank_mask:0xf
    v_and_b32_dpp v115, v17, v11 row_newbcast:5 row_mask:0xf bank_mask:0xf
    s_nop 1
    v_mfma_f32_16x16x32_bf16 v[12:15], v[112:115], v[64:67], v[12:15]
    v_and_b32_dpp v116, v18, v8 row_newbcast:5 row_mask:0xf bank_mask:0xf
    v_and_b32_dpp v117, v18, v9 row_newbcast:5 row_mask:0xf bank_mask:0xf
    v_and_b32_dpp v118, v18, v10 row_newbcast:5 row_mask:0xf bank_mask:0xf
    v_and_b32_dpp v119, v18, v11 row_newbcast:5 row_mask:0xf bank_mask:0xf
    s_nop 1
    v_mfma_f32_16x16x32_bf16 v[12:15], v[116:119], v[68:71], v[12:15]
    v_and_b32_dpp v112, v17, v8 row_newbcast:6 row_mask:0xf bank_mask:0xf
    v_and_b32_dpp v113, v17, v9 row_newbcast:6 row_mask:0xf bank_mask:0xf
    v_and_b32_dpp v114, v17, v10 row_newbcast:6 row_mask:0xf bank_mask:0xf
    v_and_b32_dpp v115, v17, v11 row_newbcast:6 row_mask:0xf bank_mask:0xf
    s_nop 1
    v_mfma_f32_16x16x32_bf16 v[12:15], v[112:115], v[72:75], v[12:15]
    v_and_b32_dpp v116, v18, v8 row_newbcast:6 row_mask:0xf bank_mask:0xf
    v_and_b32_dpp v117, v18, v9 row_newbcast:6 row_mask:0xf bank_mask:0xf
    v_and_b32_dpp v118, v18, v10 row_newbcast:6 row_mask:0xf bank_mask:0xf
    v_and_b32_dpp v119, v18, v11 row_newbcast:6 row_mask:0xf bank_mask:0xf
    s_nop 1
    v_mfma_f32_16x16x32_bf16 v[12:15], v[116:119], v[76:79], v[12:15]
    v_and_b32_dpp v112, v17, v8 row_newbcast:7 row_mask:0xf bank_mask:0xf
    v_and_b32_dpp v113, v17, v9 row_newbcast:7 row_mask:0xf bank_mask:0xf
    v_and_b32_dpp v114, v17, v10 row_newbcast:7 row_mask:0xf bank_mask:0xf
    v_and_b32_dpp v115, v17, v11 row_newbcast:7 row_mask:0xf bank_mask:0xf
    s_nop 1
    v_mfma_f32_16x16x32_bf16 v[12:15], v[112:115], v[80:83], v[12:15]
    v_and_b32_dpp v116, v18, v8 row_newbcast:7 row_mask:0xf bank_mask:0xf
    v_and_b32_dpp v117, v18, v9 row_newbcast:7 row_mask:0xf bank_mask:0xf
    v_and_b32_dpp v118, v18, v10 row_newbcast:7 row_mask:0xf bank_mask:0xf
    v_and_b32_dpp v119, v18, v11 row_newbcast:7 row_mask:0xf bank_mask:0xf
    s_nop 1
    v_mfma_f32_16x16x32_bf16 v[12:15], v[116:119], v[84:87], v[12:15]
    v_and_b32_dpp v112, v17, v8 row_newbcast:8 row_mask:0xf bank_mask:0xf
    v_and_b32_dpp v113, v17, v9 row_newbcast:8 row_mask:0xf bank_mask:0xf
    v_and_b32_dpp v114, v17, v10 row_newbcast:8 row_mask:0xf bank_mask:0xf
    v_and_b32_dpp v115, v17, v11 row_newbcast:8 row_mask:0xf bank_mask:0xf
    s_nop 1
    v_mfma_f32_16x16x32_bf16 v[12:15], v[112:115], v[88:91], v[12:15]
    v_and_b32_dpp v116, v18, v8 row_newbcast:8 row_mask:0xf bank_mask:0xf
    v_and_b32_dpp v117, v18, v9 row_newbcast:8 row_mask:0xf bank_mask:0xf
    v_and_b32_dpp v118, v18, v10 row_newbcast:8 row_mask:0xf bank_mask:0xf
    v_and_b32_dpp v119, v18, v11 row_newbcast:8 row_mask:0xf bank_mask:0xf
    s_nop 1
    v_mfma_f32_16x16x32_bf16 v[12:15], v[116:119], v[92:95], v[12:15]
    v_and_b32_dpp v112, v17, v8 row_newbcast:9 row_mask:0xf bank_mask:0xf
    v_and_b32_dpp v113, v17, v9 row_newbcast:9 row_mask:0xf bank_mask:0xf
    v_and_b32_dpp v114, v17, v10 row_newbcast:9 row_mask:0xf bank_mask:0xf
    v_and_b32_dpp v115, v17, v11 row_newbcast:9 row_mask:0xf bank_mask:0xf
    s_nop 1
    v_mfma_f32_16x16x32_bf16 v[12:15], v[112:115], v[96:99], v[12:15]
    v_and_b32_dpp v116, v18, v8 row_newbcast:9 row_mask:0xf bank_mask:0xf
    v_and_b32_dpp v117, v18, v9 row_newbcast:9 row_mask:0xf bank_mask:0xf
    v_and_b32_dpp v118, v18, v10 row_newbcast:9 row_mask:0xf bank_mask:0xf
    v_and_b32_dpp v119, v18, v11 row_newbcast:9 row_mask:0xf bank_mask:0xf
    s_nop 1
    v_mfma_f32_16x16x32_bf16 v[12:15], v[116:119], v[100:103], v[12:15]
    s_nop 7
    v_permlane32_swap_b32 v12, v14
    v_permlane32_swap_b32 v13, v15
    v_mov_b32 v120, v12
    v_mov_b32 v122, v13
    buffer_store_dwordx4 v[120:123], v16, s[52:55], s15 offen sc1
    s_lshr_b32 s15, s6, 3
    s_lshl_b32 s15, s15, 13
    s_add_u32 s15, s15, 524288
    v_and_b32 v2, 15, v1
    v_bfe_u32 v3, v1, 4, 1
    v_lshlrev_b32 v2, 2, v2
    v_lshl_add_u32 v2, v3, 1, v2
    v_bfe_u32 v3, v1, 5, 1
    v_and_b32 v20, 0xffc0, v1
    v_add3_u32 v20, v20, v2, v3
    v_lshlrev_b32 v20, 2, v20
    s_waitcnt vmcnt(0)
    s_add_u32 s64, s15, 0
    s_add_u32 s65, s15, 1024
    s_add_u32 s66, s15, 2048
    s_add_u32 s67, s15, 3072
    s_add_u32 s68, s15, 4096
    s_add_u32 s69, s15, 5120
    s_add_u32 s70, s15, 6144
    s_add_u32 s71, s15, 7168
    s_mov_b64 s[72:73], exec
L_poll_50:
    buffer_load_dwordx4 v[24:27], v16, s[52:55], s64 offen sc1
    buffer_load_dwordx4 v[28:31], v16, s[52:55], s65 offen sc1
    buffer_load_dwordx4 v[32:35], v16, s[52:55], s66 offen sc1
    buffer_load_dwordx4 v[36:39], v16, s[52:55], s67 offen sc1
    buffer_load_dwordx4 v[40:43], v16, s[52:55], s68 offen sc1
    buffer_load_dwordx4 v[44:47], v16, s[52:55], s69 offen sc1
    buffer_load_dwordx4 v[48:51], v16, s[52:55], s70 offen sc1
    buffer_load_dwordx4 v[52:55], v16, s[52:55], s71 offen sc1
    s_waitcnt vmcnt(0)
    v_xor_b32 v2, s7, v25
    v_xor_b32 v3, s7, v27
    v_or_b32 v2, v2, v3
    v_xor_b32 v3, s7, v29
    v_or_b32 v2, v2, v3
    v_xor_b32 v3, s7, v31
    v_or_b32 v2, v2, v3
    v_xor_b32 v3, s7, v33
    v_or_b32 v2, v2, v3
    v_xor_b32 v3, s7, v35
    v_or_b32 v2, v2, v3
    v_xor_b32 v3, s7, v37
    v_or_b32 v2, v2, v3
    v_xor_b32 v3, s7, v39
    v_or_b32 v2, v2, v3
    v_xor_b32 v3, s7, v41
    v_or_b32 v2, v2, v3
    v_xor_b32 v3, s7, v43
    v_or_b32 v2, v2, v3
    v_xor_b32 v3, s7, v45
    v_or_b32 v2, v2, v3
    v_xor_b32 v3, s7, v47
    v_or_b32 v2, v2, v3
    v_xor_b32 v3, s7, v49
    v_or_b32 v2, v2, v3
    v_xor_b32 v3, s7, v51
    v_or_b32 v2, v2, v3
    v_xor_b32 v3, s7, v53
    v_or_b32 v2, v2, v3
    v_xor_b32 v3, s7, v55
    v_or_b32 v2, v2, v3
    v_cmp_ne_u32 vcc, 0, v2
    s_nop 0
    s_cbranch_vccz L_pdone_51
    s_cmp_eq_u32 s8, 0
    s_cbranch_scc1 L_pdone_51
    s_sub_u32 s8, s8, 1
    s_mov_b64 exec, vcc
    s_sleep 8
    s_branch L_poll_50
L_pdone_51:
    s_mov_b64 exec, s[72:73]
    v_add_f32 v24, v24, v40
    v_add_f32 v26, v26, v42
    v_add_f32 v28, v28, v44
    v_add_f32 v30, v30, v46
    v_add_f32 v32, v32, v48
    v_add_f32 v34, v34, v50
    v_add_f32 v36, v36, v52
    v_add_f32 v38, v38, v54
    v_add_f32 v24, v24, v32
    v_add_f32 v26, v26, v34
    v_add_f32 v28, v28, v36
    v_add_f32 v30, v30, v38
    v_add_f32 v24, v24, v28
    v_add_f32 v26, v26, v30
    v_cvt_pk_bf16_f32 v24, v24, v26
    v_min_u32 v24, 0xfffffffe, v24
    ds_write_b32 v20, v24 offset:0
    s_branch L_hend
L_h2:
    v_mov_b32 v4, -1
    v_mov_b32 v5, -1
    v_lshlrev_b32 v2, 3, v1
    ds_write_b64 v2, v[4:5] offset:0
    s_waitcnt lgkmcnt(0)
    s_barrier
    s_load_dword s7, s[42:43], 0
    s_getpc_b64 s[72:73]
L_pc_52:
    s_lshl_b32 s11, s2, 2
    s_add_u32 s11, s11, role_tbl-L_pc_52
    s_load_dword s26, s[72:73], s11
    s_mov_b32 s52, s42
    s_and_b32 s53, s43, 0xffff
    s_mov_b32 s54, 786432
    s_mov_b32 s55, 0x20000
    s_mov_b32 s8, 400000
    s_mov_b32 s74, 0x05040100
    s_mov_b32 s75, 0x07060302
    s_mov_b32 s76, 0xffff0000
    s_mov_b64 s[62:63], -1
    s_getpc_b64 s[12:13]
L_pc2:
    s_bfe_u32 s14, s2, 0x10002
    s_lshl_b32 s15, s14, 9
    s_add_u32 s15, s15, ord_tbl-L_pc2
    v_lshl_add_u32 v2, v1, 2, s15
    global_load_dword v160, v2, s[12:13]
    global_load_dword v161, v2, s[12:13] offset:256
    s_and_b32 s61, s5, 1
    s_mul_i32 s14, s14, 2
    s_add_u32 s14, s14, s61
    s_mul_i32 s61, s61, 64
    s_lshl_b32 s60, s14, 7
    s_add_u32 s60, s60, 251008
    v_mov_b32 v2, 0
    v_mov_b32 v3, 0
    v_mov_b32 v4, 0
    v_mov_b32 v5, 0
    v_mov_b32 v6, 0
    v_mov_b32 v7, 0
    v_mov_b32 v8, 0
    v_mov_b32 v9, 0
    v_mov_b32 v10, 0
    v_mov_b32 v11, 0
    v_mov_b32 v12, 0
    v_mov_b32 v13, 0
    v_mov_b32 v14, 0
    v_mov_b32 v15, 0
    v_mov_b32 v16, 0
    v_mov_b32 v17, 0
    v_mov_b32 v18, 0
    v_mov_b32 v19, 0
    s_waitcnt lgkmcnt(0)
    s_mov_b32 s27, 1
    s_mov_b32 s40, 0
    s_mov_b32 s41, 0
    v_mov_b32 v44, 0
    v_mov_b32 v45, 0
    v_mov_b32 v46, 0
    v_mov_b32 v47, 0
    v_mov_b32 v48, 0
    v_mov_b32 v49, 0
    v_mov_b32 v50, 0
    v_mov_b32 v51, 0
    v_mov_b32 v52, 0
    v_mov_b32 v53, 0
    v_mov_b32 v54, 0
    v_mov_b32 v55, 0
    v_mov_b32 v68, 0
    v_mov_b32 v69, 0
    v_mov_b32 v70, 0
    v_mov_b32 v71, 0
    v_mov_b32 v72, 0
    v_mov_b32 v73, 0
    v_mov_b32 v74, 0
    v_mov_b32 v75, 0
    v_mov_b32 v76, 0
    v_mov_b32 v77, 0
    v_mov_b32 v78, 0
    v_mov_b32 v79, 0
    v_mov_b32 v80, 0
    v_mov_b32 v81, 0
    v_mov_b32 v82, 0
    v_mov_b32 v83, 0
    v_mov_b32 v84, 0
    v_mov_b32 v85, 0
    v_mov_b32 v86, 0
    v_mov_b32 v87, 0
    v_mov_b32 v88, 0
    v_mov_b32 v89, 0
    s_mov_b32 s10, 0
    s_mov_b64 s[62:63], 0
    s_mov_b64 exec, 0
    s_branch L_tail
L_dry_ret:
    s_bitcmp1_b32 s2, 2
    s_cbranch_scc1 L_dry_end
    s_add_u32 s27, s27, 1
    s_cmp_lt_u32 s27, 4
    s_cbranch_scc1 L_tail
L_dry_end:
    s_mov_b64 exec, -1
    v_and_b32 v2, 7, v1
    v_lshlrev_b32 v3, 3, v2
    s_mul_i32 s12, s6, 640
    s_add_u32 s12, s12, 81920
    s_mov_b64 s[72:73], exec
L_poll_53:
    ds_read_b64 v[8:9], v3 offset:256
    s_waitcnt lgkmcnt(0)
    v_cmp_eq_u32 vcc, -1, v8
    s_nop 0
    s_cbranch_vccz L_pdone_54
    s_cmp_eq_u32 s8, 0
    s_cbranch_scc1 L_pdone_54
    s_sub_u32 s8, s8, 1
    s_mov_b64 exec, vcc
    s_sleep 4
    s_branch L_poll_53
L_pdone_54:
    s_mov_b64 exec, s[72:73]
    s_and_b32 s13, s26, 3
    s_cmp_eq_u32 s13, 3
    s_cbranch_scc1 L_noclaim
    s_mov_b32 s14, 1
    s_atomic_add s14, s[42:43], s60 glc
L_noclaim:
    v_mov_b32 v10, v8
    s_nop 1
    v_max_f32_dpp v10, v10, v10 quad_perm:[1,0,3,2] row_mask:0xf bank_mask:0xf
    s_nop 1
    v_max_f32_dpp v10, v10, v10 quad_perm:[2,3,0,1] row_mask:0xf bank_mask:0xf
    s_nop 1
    v_max_f32_dpp v10, v10, v10 row_half_mirror row_mask:0xf bank_mask:0xf
    v_sub_f32 v4, v8, v10
    v_mul_f32 v4, 0x3fb8aa3b, v4
    v_exp_f32 v4, v4
    s_nop 0
    v_mul_f32 v11, v4, v9
    s_nop 1
    v_add_f32_dpp v11, v11, v11 quad_perm:[1,0,3,2] row_mask:0xf bank_mask:0xf
    s_nop 1
    v_add_f32_dpp v11, v11, v11 quad_perm:[2,3,0,1] row_mask:0xf bank_mask:0xf
    s_nop 1
    v_add_f32_dpp v11, v11, v11 row_half_mirror row_mask:0xf bank_mask:0xf
    v_min_u32 v10, 0xfffffffe, v10
    v_min_u32 v11, 0xfffffffe, v11
    v_mov_b32 v4, 0
    s_mov_b64 exec, 1
    buffer_store_dwordx2 v[10:11], v4, s[52:55], s12 offen offset:512 sc1
    s_mov_b64 exec, -1
    v_mov_b32 v6, 0
    v_mov_b32 v7, 0
    s_and_b32 s26, s26, 0xffffff
    s_cmp_eq_u32 s13, 3
    s_cbranch_scc1 L_rolset
    s_waitcnt lgkmcnt(0) vmcnt(1)
    s_add_u32 s14, s14, 1
    s_min_u32 s14, s14, 63
    s_add_u32 s14, s14, s61
    s_and_b32 s15, s14, 63
    v_readlane_b32 s26, v160, s15
    v_readlane_b32 s13, v161, s15
    s_bitcmp1_b32 s14, 6
    s_cselect_b32 s26, s13, s26
    s_cmp_lt_u32 s14, 128
    s_cselect_b32 s26, s26, 0
L_rolset:
    v_mov_b32 v4, s26
    ds_write_b32 v6, v4 offset:368
    s_and_b32 s27, s26, 3
    s_bfe_u32 s40, s26, 0x80008
    s_bfe_u32 s41, s26, 0x80010
    s_cmp_eq_u32 s27, 0
    s_cbranch_scc1 L_end
    s_mov_b32 s12, 250880
    s_mov_b64 s[72:73], exec
L_poll_55:
    buffer_load_dword v7, v6, s[52:55], s12 offen sc1
    s_waitcnt vmcnt(0)
    v_cmp_eq_u32 vcc, -1, v7
    s_nop 0
    s_cbranch_vccz L_pdone_56
    s_cmp_eq_u32 s8, 0
    s_cbranch_scc1 L_pdone_56
    s_sub_u32 s8, s8, 1
    s_mov_b64 exec, vcc
    s_sleep 8
    s_branch L_poll_55
L_pdone_56:
    s_mov_b64 exec, s[72:73]
    s_cmp_lg_u32 s27, 2
    s_cbranch_scc1 L_h2_sel
    s_mov_b32 s44, s16
    s_and_b32 s45, s17, 0xffff
    s_mov_b32 s46, 1280
    s_mov_b32 s47, 0x20000
    v_lshlrev_b32 v2, 2, v1
    s_mov_b32 s12, 245760
    buffer_load_dword v55, v2, s[44:47], 0 offen offset:0
    buffer_load_dword v56, v2, s[44:47], 0 offen offset:256
    buffer_load_dword v57, v2, s[44:47], 0 offen offset:512
    buffer_load_dword v58, v2, s[44:47], 0 offen offset:768
    buffer_load_dword v59, v2, s[44:47], 0 offen offset:1024
    s_mov_b64 s[72:73], exec
L_poll_57:
    buffer_load_dword v40, v2, s[52:55], s12 offen offset:0 sc1
    buffer_load_dword v41, v2, s[52:55], s12 offen offset:256 sc1
    buffer_load_dword v42, v2, s[52:55], s12 offen offset:512 sc1
    buffer_load_dword v43, v2, s[52:55], s12 offen offset:768 sc1
    buffer_load_dword v44, v2, s[52:55], s12 offen offset:1024 sc1
    buffer_load_dword v45, v2, s[52:55], s12 offen offset:1280 sc1
    buffer_load_dword v46, v2, s[52:55], s12 offen offset:1536 sc1
    buffer_load_dword v47, v2, s[52:55], s12 offen offset:1792 sc1
    buffer_load_dword v48, v2, s[52:55], s12 offen offset:2048 sc1
    buffer_load_dword v49, v2, s[52:55], s12 offen offset:2304 sc1
    buffer_load_dword v50, v2, s[52:55], s12 offen offset:2560 sc1
    buffer_load_dword v51, v2, s[52:55], s12 offen offset:2816 sc1
    buffer_load_dword v52, v2, s[52:55], s12 offen offset:3072 sc1
    buffer_load_dword v53, v2, s[52:55], s12 offen offset:3328 sc1
    buffer_load_dword v54, v2, s[52:55], s12 offen offset:3584 sc1
    s_waitcnt vmcnt(0)
    v_max3_u32 v4, v40, v41, v42
    v_max3_u32 v4, v4, v43, v44
    v_max3_u32 v4, v4, v45, v46
    v_max3_u32 v4, v4, v47, v48
    v_max3_u32 v4, v4, v49, v50
    v_max3_u32 v4, v4, v51, v52
    v_max3_u32 v4, v4, v53, v54
    v_cmp_eq_u32 vcc, -1, v4
    s_nop 0
    s_cbranch_vccz L_pdone_58
    s_cmp_eq_u32 s8, 0
    s_cbranch_scc1 L_pdone_58
    s_sub_u32 s8, s8, 1
    s_mov_b64 exec, vcc
    s_sleep 8
    s_branch L_poll_57
L_pdone_58:
    s_mov_b64 exec, s[72:73]
    ds_write_b32 v2, v40 offset:10880
    ds_write_b32 v2, v41 offset:11136
    ds_write_b32 v2, v42 offset:11392
    ds_write_b32 v2, v43 offset:11648
    ds_write_b32 v2, v44 offset:11904
    ds_write_b32 v2, v45 offset:12160
    ds_write_b32 v2, v46 offset:12416
    ds_write_b32 v2, v47 offset:12672
    ds_write_b32 v2, v48 offset:12928
    ds_write_b32 v2, v49 offset:13184
    ds_write_b32 v2, v50 offset:13440
    ds_write_b32 v2, v51 offset:13696
    ds_write_b32 v2, v52 offset:13952
    ds_write_b32 v2, v53 offset:14208
    ds_write_b32 v2, v54 offset:14464
    ds_write_b32 v2, v55 offset:14720
    ds_write_b32 v2, v56 offset:14976
    ds_write_b32 v2, v57 offset:15232
    ds_write_b32 v2, v58 offset:15488
    ds_write_b32 v2, v59 offset:15744
L_h2_sel:
    ds_write_b32 v6, v7 offset:364
    s_endpgm
L_h3:
    s_barrier
    s_waitcnt lgkmcnt(0)
    s_mul_i32 s7, s7, 1664525
    s_add_u32 s7, s7, 1013904223
    v_mov_b32 v2, 0
    ds_write_b32 v2, v2 offset:348
    s_cmp_lg_u32 s2, 64
    s_cbranch_scc1 L_nodec
    s_add_u32 s12, s42, 0x100000
    s_addc_u32 s13, s43, 0
    s_mov_b32 s14, 0
    s_memtime s[64:65]
    s_waitcnt lgkmcnt(0)
    s_load_dword s44, s[12:13], 0
    s_load_dword s45, s[12:13], 5120
    s_load_dword s46, s[12:13], 2048
    s_load_dword s47, s[12:13], 7168
    s_waitcnt lgkmcnt(3)
    s_memtime s[66:67]
    s_waitcnt lgkmcnt(0)
    s_sub_u32 s15, s66, s64
    s_min_u32 s15, s15, 4000
    s_sub_u32 s14, s14, s15
    s_memtime s[64:65]
    s_waitcnt lgkmcnt(0)
    s_load_dword s44, s[12:13], 8192
    s_load_dword s45, s[12:13], 13312
    s_load_dword s46, s[12:13], 10240
    s_load_dword s47, s[12:13], 15360
    s_waitcnt lgkmcnt(3)
    s_memtime s[66:67]
    s_waitcnt lgkmcnt(0)
    s_sub_u32 s15, s66, s64
    s_min_u32 s15, s15, 4000
    s_add_u32 s14, s14, s15
    s_memtime s[64:65]
    s_waitcnt lgkmcnt(0)
    s_load_dword s44, s[12:13], 24576
    s_load_dword s45, s[12:13], 29696
    s_load_dword s46, s[12:13], 26624
    s_load_dword s47, s[12:13], 31744
    s_waitcnt lgkmcnt(3)
    s_memtime s[66:67]
    s_waitcnt lgkmcnt(0)
    s_sub_u32 s15, s66, s64
    s_min_u32 s15, s15, 4000
    s_add_u32 s14, s14, s15
    s_memtime s[64:65]
    s_waitcnt lgkmcnt(0)
    s_load_dword s44, s[12:13], 16384
    s_load_dword s45, s[12:13], 21504
    s_load_dword s46, s[12:13], 18432
    s_load_dword s47, s[12:13], 23552
    s_waitcnt lgkmcnt(3)
    s_memtime s[66:67]
    s_waitcnt lgkmcnt(0)
    s_sub_u32 s15, s66, s64
    s_min_u32 s15, s15, 4000
    s_sub_u32 s14, s14, s15
    s_memtime s[64:65]
    s_waitcnt lgkmcnt(0)
    s_load_dword s44, s[12:13], 32768
    s_load_dword s45, s[12:13], 37888
    s_load_dword s46, s[12:13], 34816
    s_load_dword s47, s[12:13], 39936
    s_waitcnt lgkmcnt(3)
    s_memtime s[66:67]
    s_waitcnt lgkmcnt(0)
    s_sub_u32 s15, s66, s64
    s_min_u32 s15, s15, 4000
    s_sub_u32 s14, s14, s15
    s_memtime s[64:65]
    s_waitcnt lgkmcnt(0)
    s_load_dword s44, s[12:13], 40960
    s_load_dword s45, s[12:13], 46080
    s_load_dword s46, s[12:13], 43008
    s_load_dword s47, s[12:13], 48128
    s_waitcnt lgkmcnt(3)
    s_memtime s[66:67]
    s_waitcnt lgkmcnt(0)
    s_sub_u32 s15, s66, s64
    s_min_u32 s15, s15, 4000
    s_add_u32 s14, s14, s15
    s_memtime s[64:65]
    s_waitcnt lgkmcnt(0)
    s_load_dword s44, s[12:13], 57344
    s_load_dword s45, s[12:13], 62464
    s_load_dword s46, s[12:13], 59392
    s_load_dword s47, s[12:13], 64512
    s_waitcnt lgkmcnt(3)
    s_memtime s[66:67]
    s_waitcnt lgkmcnt(0)
    s_sub_u32 s15, s66, s64
    s_min_u32 s15, s15, 4000
    s_add_u32 s14, s14, s15
    s_memtime s[64:65]
    s_waitcnt lgkmcnt(0)
    s_load_dword s44, s[12:13], 49152
    s_load_dword s45, s[12:13], 54272
    s_load_dword s46, s[12:13], 51200
    s_load_dword s47, s[12:13], 56320
    s_waitcnt lgkmcnt(3)
    s_memtime s[66:67]
    s_waitcnt lgkmcnt(0)
    s_sub_u32 s15, s66, s64
    s_min_u32 s15, s15, 4000
    s_sub_u32 s14, s14, s15
    s_cmp_gt_i32 s14, 0
    s_cselect_b32 s14, 0, 8192
    v_and_b32 v2, 0, v1
    v_lshlrev_b32 v2, 2, v2
    s_mov_b64 s[72:73], exec
L_poll_59:
    ds_read_b32 v3, v2 offset:0
    s_waitcnt lgkmcnt(0)
    v_cmp_eq_u32 vcc, -1, v3
    s_nop 0
    s_cbranch_vccz L_pdone_60
    s_cmp_eq_u32 s8, 0
    s_cbranch_scc1 L_pdone_60
    s_sub_u32 s8, s8, 1
    s_mov_b64 exec, vcc
    s_sleep 8
    s_branch L_poll_59
L_pdone_60:
    s_mov_b64 exec, s[72:73]
    v_mov_b32 v2, 0
    v_mov_b32 v3, s14
    s_mov_b32 s12, 250880
    s_mov_b64 exec, 1
    buffer_store_dword v3, v2, s[52:55], s12 offen sc1
    s_endpgm
L_nodec:
    s_lshr_b32 s14, s26, 24
    s_cmp_eq_u32 s14, 255
    s_cbranch_scc1 L_end
    v_and_b32 v2, 0, v1
    v_lshlrev_b32 v2, 2, v2
    s_mov_b64 s[72:73], exec
L_poll_61:
    ds_read_b32 v3, v2 offset:0
    s_waitcnt lgkmcnt(0)
    v_cmp_eq_u32 vcc, -1, v3
    s_nop 0
    s_cbranch_vccz L_pdone_62
    s_cmp_eq_u32 s8, 0
    s_cbranch_scc1 L_pdone_62
    s_sub_u32 s8, s8, 1
    s_mov_b64 exec, vcc
    s_sleep 8
    s_branch L_poll_61
L_pdone_62:
    s_mov_b64 exec, s[72:73]
    s_lshl_b32 s15, s14, 10
    s_add_u32 s15, s15, 272384
    v_lshlrev_b32 v8, 4, v1
    v_and_b32 v2, 15, v1
    v_bfe_u32 v3, v1, 4, 1
    v_lshlrev_b32 v2, 2, v2
    v_lshl_add_u32 v2, v3, 1, v2
    v_bfe_u32 v3, v1, 5, 1
    v_and_b32 v9, 0xffc0, v1
    v_add3_u32 v9, v9, v2, v3
    v_lshlrev_b32 v9, 2, v9
    s_add_u32 s64, s15, 0
    s_add_u32 s65, s15, 30720
    s_add_u32 s66, s15, 61440
    s_add_u32 s67, s15, 92160
    s_add_u32 s68, s15, 122880
    s_add_u32 s69, s15, 153600
    s_add_u32 s70, s15, 184320
    s_add_u32 s71, s15, 215040
    s_mov_b64 s[72:73], exec
L_poll_63:
    buffer_load_dwordx4 v[40:43], v8, s[52:55], s64 offen sc1
    buffer_load_dwordx4 v[44:47], v8, s[52:55], s65 offen sc1
    buffer_load_dwordx4 v[48:51], v8, s[52:55], s66 offen sc1
    buffer_load_dwordx4 v[52:55], v8, s[52:55], s67 offen sc1
    buffer_load_dwordx4 v[56:59], v8, s[52:55], s68 offen sc1
    buffer_load_dwordx4 v[60:63], v8, s[52:55], s69 offen sc1
    buffer_load_dwordx4 v[64:67], v8, s[52:55], s70 offen sc1
    buffer_load_dwordx4 v[68:71], v8, s[52:55], s71 offen sc1
    s_waitcnt vmcnt(0)
    v_xor_b32 v2, s7, v41
    v_xor_b32 v3, s7, v43
    v_or_b32 v2, v2, v3
    v_xor_b32 v3, s7, v45
    v_or_b32 v2, v2, v3
    v_xor_b32 v3, s7, v47
    v_or_b32 v2, v2, v3
    v_xor_b32 v3, s7, v49
    v_or_b32 v2, v2, v3
    v_xor_b32 v3, s7, v51
    v_or_b32 v2, v2, v3
    v_xor_b32 v3, s7, v53
    v_or_b32 v2, v2, v3
    v_xor_b32 v3, s7, v55
    v_or_b32 v2, v2, v3
    v_xor_b32 v3, s7, v57
    v_or_b32 v2, v2, v3
    v_xor_b32 v3, s7, v59
    v_or_b32 v2, v2, v3
    v_xor_b32 v3, s7, v61
    v_or_b32 v2, v2, v3
    v_xor_b32 v3, s7, v63
    v_or_b32 v2, v2, v3
    v_xor_b32 v3, s7, v65
    v_or_b32 v2, v2, v3
    v_xor_b32 v3, s7, v67
    v_or_b32 v2, v2, v3
    v_xor_b32 v3, s7, v69
    v_or_b32 v2, v2, v3
    v_xor_b32 v3, s7, v71
    v_or_b32 v2, v2, v3
    v_cmp_ne_u32 vcc, 0, v2
    s_nop 0
    s_cbranch_vccz L_pdone_64
    s_cmp_eq_u32 s8, 0
    s_cbranch_scc1 L_pdone_64
    s_sub_u32 s8, s8, 1
    s_mov_b64 exec, vcc
    s_sleep 8
    s_branch L_poll_63
L_pdone_64:
    s_mov_b64 exec, s[72:73]
    v_add_f32 v40, v40, v56
    v_add_f32 v42, v42, v58
    v_add_f32 v44, v44, v60
    v_add_f32 v46, v46, v62
    v_add_f32 v48, v48, v64
    v_add_f32 v50, v50, v66
    v_add_f32 v52, v52, v68
    v_add_f32 v54, v54, v70
    v_add_f32 v40, v40, v48
    v_add_f32 v42, v42, v50
    v_add_f32 v44, v44, v52
    v_add_f32 v46, v46, v54
    v_add_f32 v40, v40, v44
    v_add_f32 v42, v42, v46
    v_cvt_pk_bf16_f32 v40, v40, v42
    v_min_u32 v40, 0xfffffffe, v40
    s_lshl_b32 s15, s14, 8
    s_add_u32 s15, s15, 245760
    buffer_store_dword v40, v9, s[52:55], s15 offen sc1
    s_endpgm
L_hend:
    s_endpgm
.p2align 6
.type role_tbl,@object
role_tbl:
    .long 0xff060401, 0xff000002, 0xff060501, 0xff000102, 0xff000001, 0xff000000, 0xff000101, 0xff000000
    .long 0xff060601, 0xff000202, 0xff060701, 0xff000302, 0xff000201, 0xff000000, 0xff000301, 0xff000000
    .long 0xff060801, 0xff000402, 0xff060901, 0xff000502, 0xff000401, 0xff000000, 0xff000501, 0xff000000
    .long 0xff070001, 0xff000602, 0xff070101, 0xff000702, 0xff000601, 0xff000000, 0xff000701, 0xff000000
    .long 0xff070201, 0xff000802, 0xff070301, 0xff000902, 0xff000801, 0xff000000, 0xff000901, 0xff000000
    .long 0xff070401, 0xff000a02, 0xff070501, 0xff000b02, 0xff010001, 0xff000000, 0xff010101, 0xff000000
    .long 0xff070601, 0xff000c02, 0xff070701, 0xff000d02, 0xff010201, 0xff000000, 0xff010301, 0xff000000
    .long 0xff070801, 0xff000e02, 0xff070901, 0xff000f02, 0xff010401, 0xff000000, 0xff010501, 0xff000000
    .long 0xff000000, 0xff001002, 0xff000000, 0xff001102, 0xff010601, 0xff000000, 0xff010701, 0xff000000
    .long 0xff000000, 0xff001202, 0xff000000, 0xff001302, 0xff010801, 0xff000000, 0xff010901, 0xff000000
    .long 0xff000000, 0xff001402, 0xff000000, 0xff001502, 0xff020001, 0xff000000, 0xff020101, 0xff000000
    .long 0xff000000, 0xff001602, 0xff000000, 0xff001702, 0xff020201, 0xff000000, 0xff020301, 0xff000000
    .long 0xff002303, 0xff001802, 0xff002703, 0xff001902, 0xff020401, 0xff000000, 0xff020501, 0xff000000
    .long 0xff002203, 0xff001a02, 0xff002603, 0xff001b02, 0xff020601, 0xff000000, 0xff020701, 0xff000000
    .long 0xff002103, 0xff001c02, 0xff002503, 0xff001d02, 0xff020801, 0xff000000, 0xff020901, 0xff000000
    .long 0xff002003, 0xff001e02, 0xff002403, 0xff001f02, 0xff030001, 0xff000000, 0xff030101, 0xff000000
    .long 0xff001b03, 0xff002002, 0xff001f03, 0xff002102, 0xff030201, 0xff000000, 0xff030301, 0xff000000
    .long 0xff001a03, 0xff002202, 0xff001e03, 0xff002302, 0xff030401, 0xff000000, 0xff030501, 0xff000000
    .long 0xff001903, 0xff002402, 0xff001d03, 0xff002502, 0xff030601, 0xff000000, 0xff030701, 0xff000000
    .long 0xff001803, 0xff002602, 0xff001c03, 0xff002702, 0xff030801, 0xff000000, 0xff030901, 0xff000000
    .long 0xff001303, 0xff002802, 0xff001703, 0xff002902, 0xff040001, 0xff000000, 0xff040101, 0xff000000
    .long 0xff001203, 0xff002a02, 0xff001603, 0xff002b02, 0xff040201, 0xff000000, 0xff040301, 0xff000000
    .long 0xff001103, 0xff002c02, 0xff001503, 0xff002d02, 0xff040401, 0xff000000, 0xff040501, 0xff000000
    .long 0xff001003, 0xff002e02, 0xff001403, 0xff002f02, 0xff040601, 0xff000000, 0xff040701, 0xff000000
    .long 0xff000b03, 0xff003002, 0xff000f03, 0xff003102, 0xff040801, 0xff000000, 0xff040901, 0xff000000
    .long 0xff000a03, 0xff003202, 0xff000e03, 0xff003302, 0xff050001, 0xff000000, 0xff050101, 0xff000000
    .long 0xff000903, 0xff003402, 0xff000d03, 0xff003502, 0xff050201, 0xff000000, 0xff050301, 0xff000000
    .long 0xff000803, 0xff000000, 0xff000c03, 0xff000000, 0xff050401, 0xff000000, 0xff050501, 0xff000000
    .long 0xff000303, 0xff000000, 0xff000703, 0xff000000, 0xff050601, 0xff000000, 0xff050701, 0xff000000
    .long 0x10000203, 0x11000000, 0x12000603, 0x13000000, 0xff050801, 0xff000000, 0xff050901, 0xff000000
    .long 0x00000103, 0x01000000, 0x02000503, 0x03000000, 0x04060001, 0x05000000, 0x06060101, 0x07000000
    .long 0x08000003, 0x09000000, 0x0a000403, 0x0b000000, 0x0c060201, 0x0d000000, 0x0e060301, 0x0f000000
.size role_tbl, 1024
.type ord_tbl,@object
ord_tbl:
    .long 0x00000001, 0x00000201, 0x00000401, 0x00000601, 0x00000801, 0x00010001, 0x00010201, 0x00010401
    .long 0x00000002, 0x00000202, 0x00000402, 0x00000602, 0x00000802, 0x00000a02, 0x00000c02, 0x00000e02
    .long 0x00001002, 0x00001202, 0x00001402, 0x00001602, 0x00001802, 0x00001a02, 0x00001c02, 0x00001e02
    .long 0x00002002, 0x00002202, 0x00002402, 0x00002602, 0x00002802, 0x00002a02, 0x00002c02, 0x00002e02
    .long 0x00003002, 0x00003202, 0x00003402, 0x00000000, 0x00000000, 0x00000000, 0x00000000, 0x00000000
    .long 0x00000000, 0x00000000, 0x00000000, 0x00000000, 0x00000000, 0x00000000, 0x00000000, 0x00000000
    .long 0x00000000, 0x00000000, 0x00000000, 0x00000000, 0x00000000, 0x00000000, 0x00000000, 0x00000000
    .long 0x00000000, 0x00000000, 0x00000000, 0x00000000, 0x00000000, 0x00000000, 0x00000000, 0x00000000
    .long 0x00000101, 0x00000301, 0x00000501, 0x00000701, 0x00000901, 0x00010101, 0x00010301, 0x00010501
    .long 0x00000102, 0x00000302, 0x00000502, 0x00000702, 0x00000902, 0x00000b02, 0x00000d02, 0x00000f02
    .long 0x00001102, 0x00001302, 0x00001502, 0x00001702, 0x00001902, 0x00001b02, 0x00001d02, 0x00001f02
    .long 0x00002102, 0x00002302, 0x00002502, 0x00002702, 0x00002902, 0x00002b02, 0x00002d02, 0x00002f02
    .long 0x00003102, 0x00003302, 0x00003502, 0x00000000, 0x00000000, 0x00000000, 0x00000000, 0x00000000
    .long 0x00000000, 0x00000000, 0x00000000, 0x00000000, 0x00000000, 0x00000000, 0x00000000, 0x00000000
    .long 0x00000000, 0x00000000, 0x00000000, 0x00000000, 0x00000000, 0x00000000, 0x00000000, 0x00000000
    .long 0x00000000, 0x00000000, 0x00000000, 0x00000000, 0x00000000, 0x00000000, 0x00000000, 0x00000000
    .long 0x00010601, 0x00010801, 0x00020001, 0x00020201, 0x00020401, 0x00020601, 0x00020801, 0x00030001
    .long 0x00030201, 0x00030401, 0x00030601, 0x00030801, 0x00040001, 0x00040201, 0x00040401, 0x00040601
    .long 0x00040801, 0x00050001, 0x00050201, 0x00050401, 0x00050601, 0x00050801, 0x00060001, 0x00060201
    .long 0x00060401, 0x00060601, 0x00060801, 0x00070001, 0x00070201, 0x00070401, 0x00070601, 0x00070801
    .long 0x00000000, 0x00000000, 0x00000000, 0x00000000, 0x00000000, 0x00000000, 0x00000000, 0x00000000
    .long 0x00000000, 0x00000000, 0x00000000, 0x00000000, 0x00000000, 0x00000000, 0x00000000, 0x00000000
    .long 0x00000000, 0x00000000, 0x00000000, 0x00000000, 0x00000000, 0x00000000, 0x00000000, 0x00000000
    .long 0x00000000, 0x00000000, 0x00000000, 0x00000000, 0x00000000, 0x00000000, 0x00000000, 0x00000000
    .long 0x00010701, 0x00010901, 0x00020101, 0x00020301, 0x00020501, 0x00020701, 0x00020901, 0x00030101
    .long 0x00030301, 0x00030501, 0x00030701, 0x00030901, 0x00040101, 0x00040301, 0x00040501, 0x00040701
    .long 0x00040901, 0x00050101, 0x00050301, 0x00050501, 0x00050701, 0x00050901, 0x00060101, 0x00060301
    .long 0x00060501, 0x00060701, 0x00060901, 0x00070101, 0x00070301, 0x00070501, 0x00070701, 0x00070901
    .long 0x00000000, 0x00000000, 0x00000000, 0x00000000, 0x00000000, 0x00000000, 0x00000000, 0x00000000
    .long 0x00000000, 0x00000000, 0x00000000, 0x00000000, 0x00000000, 0x00000000, 0x00000000, 0x00000000
    .long 0x00000000, 0x00000000, 0x00000000, 0x00000000, 0x00000000, 0x00000000, 0x00000000, 0x00000000
    .long 0x00000000, 0x00000000, 0x00000000, 0x00000000, 0x00000000, 0x00000000, 0x00000000, 0x00000000
.size ord_tbl, 1024
.section .rodata,"a"
.p2align 6
.amdhsa_kernel adaLN_cond__gqa_block_cached__swiglu_ffn__decode_kernel
  .amdhsa_next_free_vgpr 168
  .amdhsa_next_free_sgpr 102
  .amdhsa_accum_offset 168
  .amdhsa_group_segment_fixed_size 0
  .amdhsa_kernarg_size 112
  .amdhsa_user_sgpr_count 2
  .amdhsa_user_sgpr_kernarg_segment_ptr 1
  .amdhsa_system_sgpr_workgroup_id_x 1
  .amdhsa_float_denorm_mode_32 3
.end_amdhsa_kernel
```
